```python
import torch

def _softmax(x, axis=-1):
    return torch.softmax(x, dim=axis)
def _gelu(x):
    return torch.nn.functional.gelu(x, approximate="tanh")
def _silu(x):
    return torch.nn.functional.silu(x)
def _sigmoid(x):
    return torch.sigmoid(x)
def _layernorm(x, axis=-1, eps=1e-5):
    m = x.mean(dim=axis, keepdim=True)
    v = x.var(dim=axis, keepdim=True, unbiased=False)
    return (x - m) / torch.sqrt(v + eps)
def _scatter_add(tgt, idx, src, axis=0):
    return tgt.clone().index_add_(axis, idx, src)
def _segment_sum(src, seg, n):
    out = torch.zeros((n,) + src.shape[1:], dtype=src.dtype)
    return out.index_add_(0, seg, src)
def _pad(x, pw):
    flat = tuple(v for pair in reversed(pw) for v in pair)
    return torch.nn.functional.pad(x, flat)

kernel_name = 'standalone__gqa_softmax__decode'

def setup_inputs():

    _w = (lambda a: (lambda t: t.to(torch.bfloat16) if t.is_floating_point() else t)(torch.as_tensor(a)))
    B, Hq, Hkv, Sq, Sk, D = 8, 32, 8, 1, 8192, 128
    return {
        "q": _w((lambda *s: torch.randn(*s, dtype=torch.bfloat16) * 0.8)(B, Hq, Sq, D)),
        "k": _w((lambda *s: torch.randn(*s, dtype=torch.bfloat16) * 0.8)(B, Hkv, Sk, D)),
        "v": _w((lambda *s: torch.randn(*s, dtype=torch.bfloat16) * 0.05)(B, Hkv, Sk, D)),
    }

def reference(q, k, v):
    B, Hq, Sq, D = q.shape
    Hkv = k.shape[1]
    rep = Hq // Hkv
    k = (lambda x, n, axis: torch.repeat_interleave(x, n, dim=axis))(k, rep, axis=1)
    v = (lambda x, n, axis: torch.repeat_interleave(x, n, dim=axis))(v, rep, axis=1)
    scale = D ** -0.5
    scores = torch.einsum("bhqd,bhkd->bhqk", q, k) * scale
    p = _softmax(scores, axis=-1)
    return torch.einsum("bhqk,bhkd->bhqd", p, v)
```

```asm
; @launch grid=(256,1,1) block=(192,1,1) lds=39936
.amdgcn_target "amdgcn-amd-amdhsa--gfx950"
.text
.globl standalone__gqa_softmax__decode_kernel
.p2align 8
.type standalone__gqa_softmax__decode_kernel,@function
standalone__gqa_softmax__decode_kernel:
    s_cmp_ge_u32 s2, 256
    s_cbranch_scc1 L_exit
    s_load_dwordx8 s[4:11], s[0:1], 0
    s_load_dwordx4 s[12:15], s[0:1], 32
    v_lshrrev_b32 v3, 6, v0
    v_and_b32 v2, 63, v0
    v_readfirstlane_b32 s38, v3
    s_and_b32 s36, s2, 3
    s_lshl_b32 s36, s36, 1
    s_bfe_u32 s39, s2, 0x10003
    s_or_b32 s36, s36, s39
    s_lshr_b32 s39, s2, 1
    s_and_b32 s39, s39, 0x18
    s_or_b32 s36, s36, s39
    s_lshl_b32 s39, s2, 3
    s_and_b32 s39, s39, 0x20
    s_or_b32 s36, s36, s39
    s_lshr_b32 s37, s2, 6
    v_and_b32 v3, 3, v0
    v_bfe_u32 v4, v0, 2, 2
    v_bfe_u32 v5, v0, 4, 2
    v_lshlrev_b32 v5, 6, v5
    v_lshl_add_u32 v1, v4, 8, v5
    v_lshl_add_u32 v1, v3, 4, v1
    v_lshl_add_u32 v5, v3, 8, v5
    v_lshl_add_u32 v5, v4, 4, v5
    v_lshlrev_b32 v2, 4, v2
    s_lshl_b32 s39, s36, 21
    s_lshl_b32 s40, s37, 19
    s_add_u32 s39, s39, s40
    s_lshl_b32 s41, s38, 13
    s_and_b32 s40, s2, 7
    s_mul_i32 s40, s40, 16384
    s_add_u32 s41, s41, s40
    s_mov_b32 s42, s41
    s_mov_b32 s18, 524288
    s_mov_b32 s19, 0x20000
    s_mov_b32 s26, 1024
    s_mov_b32 s27, 0x20000
    s_lshl_b32 s61, s36, 10
    s_cmp_eq_u32 s38, 2
    s_waitcnt lgkmcnt(0)
    s_cbranch_scc1 L_helper
    s_add_u32 s16, s6, s39
    s_addc_u32 s17, s7, 0
    s_add_u32 s24, s4, s61
    s_addc_u32 s25, s5, 0
    buffer_load_dwordx4 v[8:11], v5, s[24:27], 0 offen
    buffer_load_dwordx4 v[132:135], v1, s[16:19], s41 offen offset:0 nt
    buffer_load_dwordx4 v[136:139], v1, s[16:19], s41 offen offset:1024 nt
    buffer_load_dwordx4 v[140:143], v1, s[16:19], s41 offen offset:2048 nt
    buffer_load_dwordx4 v[144:147], v1, s[16:19], s41 offen offset:3072 nt
    s_add_u32 s41, s41, 4096
    buffer_load_dwordx4 v[148:151], v1, s[16:19], s41 offen offset:0 nt
    buffer_load_dwordx4 v[152:155], v1, s[16:19], s41 offen offset:1024 nt
    buffer_load_dwordx4 v[156:159], v1, s[16:19], s41 offen offset:2048 nt
    buffer_load_dwordx4 v[160:163], v1, s[16:19], s41 offen offset:3072 nt
    s_add_u32 s41, s41, 12288
    s_and_b32 s41, s41, 524287
    buffer_load_dwordx4 v[164:167], v1, s[16:19], s41 offen offset:0 nt
    buffer_load_dwordx4 v[168:171], v1, s[16:19], s41 offen offset:1024 nt
    s_add_u32 s20, s8, s39
    s_addc_u32 s21, s9, 0
    s_mov_b32 s22, 524288
    s_mov_b32 s23, 0x20000
    s_mov_b32 s28, s14
    s_mov_b32 s29, s15
    s_mov_b32 s30, 1048576
    s_mov_b32 s31, 0x20000
    s_lshl_b32 s58, s36, 14
    s_lshl_b32 s54, s37, 12
    s_add_u32 s54, s54, s58
    s_mul_i32 s40, s38, 18432
    v_add_u32 v128, s40, v2
    v_add_u32 v129, s40, v2
    v_mov_b32 v6, 0xff800000
    v_mov_b32 v7, 0
    s_mov_b32 s43, 0x05040100
    s_mov_b32 s44, 0x07060302
    s_mov_b32 s45, 0x3e0293ee
    s_mov_b32 s46, 0x000f000f
    s_mov_b32 s47, s46
    s_lshl_b64 s[48:49], s[46:47], 4
    s_lshl_b64 s[50:51], s[46:47], 8
    s_lshl_b64 s[52:53], s[46:47], 12
    s_xor_b32 s55, s54, 4096
    s_xor_b32 s56, s54, 8192
    s_xor_b32 s57, s54, 12288
    s_mov_b32 s32, s10
    s_mov_b32 s33, s11
    s_mov_b32 s34, 65536
    s_mov_b32 s35, 0x20000
    s_waitcnt vmcnt(9)
    buffer_load_dwordx4 v[172:175], v1, s[16:19], s41 offen offset:2048 nt
    v_mfma_f32_16x16x32_bf16 v[88:91], v[132:135], v[8:11], 0
    buffer_load_dwordx4 v[176:179], v1, s[16:19], s41 offen offset:3072 nt
    s_add_u32 s41, s41, 4096
    s_waitcnt vmcnt(9)
    buffer_load_dwordx4 v[180:183], v1, s[16:19], s41 offen offset:0 nt
    v_mfma_f32_16x16x32_bf16 v[92:95], v[136:139], v[8:11], 0
    buffer_load_dwordx4 v[184:187], v1, s[16:19], s41 offen offset:1024 nt
    v_mfma_f32_16x16x32_bf16 v[96:99], v[140:143], v[8:11], 0
    s_nop 0
    v_mov_b32_dpp v120, v88 quad_perm:[0,1,2,3] row_mask:0xf bank_mask:0x1
    s_waitcnt vmcnt(9)
    buffer_load_dwordx4 v[188:191], v1, s[16:19], s41 offen offset:2048 nt
    v_mfma_f32_16x16x32_bf16 v[100:103], v[144:147], v[8:11], 0
    s_nop 0
    v_mov_b32_dpp v121, v92 quad_perm:[0,1,2,3] row_mask:0xf bank_mask:0x1
    v_add_f32_dpp v120, v89, v120 row_ror:12 row_mask:0xf bank_mask:0x1
    buffer_load_dwordx4 v[192:195], v1, s[16:19], s41 offen offset:3072 nt
    s_add_u32 s41, s41, 12288
    s_and_b32 s41, s41, 524287
    v_mfma_f32_16x16x32_bf16 v[104:107], v[148:151], v[8:11], 0
    v_mov_b32_dpp v122, v96 quad_perm:[0,1,2,3] row_mask:0xf bank_mask:0x1
    v_add_f32_dpp v121, v93, v121 row_ror:12 row_mask:0xf bank_mask:0x1
    v_add_f32_dpp v120, v90, v120 row_ror:8 row_mask:0xf bank_mask:0x1
    s_waitcnt vmcnt(9)
    buffer_load_dwordx4 v[132:135], v1, s[16:19], s41 offen offset:0 nt
    v_mfma_f32_16x16x32_bf16 v[108:111], v[152:155], v[8:11], 0
    v_mov_b32_dpp v123, v100 quad_perm:[0,1,2,3] row_mask:0xf bank_mask:0x1
    v_add_f32_dpp v122, v97, v122 row_ror:12 row_mask:0xf bank_mask:0x1
    v_add_f32_dpp v121, v94, v121 row_ror:8 row_mask:0xf bank_mask:0x1
    v_add_f32_dpp v120, v91, v120 row_ror:4 row_mask:0xf bank_mask:0x1
    s_mov_b32 s60, 7
L_loop0:
    buffer_load_dwordx4 v[136:139], v1, s[16:19], s41 offen offset:1024 nt
    v_mfma_f32_16x16x32_bf16 v[112:115], v[156:159], v[8:11], 0
    v_mov_b32_dpp v124, v104 quad_perm:[0,1,2,3] row_mask:0xf bank_mask:0x1
    v_add_f32_dpp v123, v101, v123 row_ror:12 row_mask:0xf bank_mask:0x1
    v_add_f32_dpp v122, v98, v122 row_ror:8 row_mask:0xf bank_mask:0x1
    v_add_f32_dpp v121, v95, v121 row_ror:4 row_mask:0xf bank_mask:0x1
    s_waitcnt vmcnt(9)
    buffer_load_dwordx4 v[140:143], v1, s[16:19], s41 offen offset:2048 nt
    v_mfma_f32_16x16x32_bf16 v[116:119], v[160:163], v[8:11], 0
    v_mov_b32_dpp v125, v108 quad_perm:[0,1,2,3] row_mask:0xf bank_mask:0x1
    v_add_f32_dpp v124, v105, v124 row_ror:12 row_mask:0xf bank_mask:0x1
    v_add_f32_dpp v123, v102, v123 row_ror:8 row_mask:0xf bank_mask:0x1
    v_add_f32_dpp v122, v99, v122 row_ror:4 row_mask:0xf bank_mask:0x1
    buffer_load_dwordx4 v[144:147], v1, s[16:19], s41 offen offset:3072 nt
    s_add_u32 s41, s41, 4096
    v_mfma_f32_16x16x32_bf16 v[88:91], v[164:167], v[8:11], 0
    v_mov_b32_dpp v126, v112 quad_perm:[0,1,2,3] row_mask:0xf bank_mask:0x1
    v_add_f32_dpp v125, v109, v125 row_ror:12 row_mask:0xf bank_mask:0x1
    v_add_f32_dpp v124, v106, v124 row_ror:8 row_mask:0xf bank_mask:0x1
    v_add_f32_dpp v123, v103, v123 row_ror:4 row_mask:0xf bank_mask:0x1
    s_waitcnt vmcnt(9)
    buffer_load_dwordx4 v[148:151], v1, s[16:19], s41 offen offset:0 nt
    v_mfma_f32_16x16x32_bf16 v[92:95], v[168:171], v[8:11], 0
    v_mov_b32_dpp v127, v116 quad_perm:[0,1,2,3] row_mask:0xf bank_mask:0x1
    v_add_f32_dpp v126, v113, v126 row_ror:12 row_mask:0xf bank_mask:0x1
    v_add_f32_dpp v125, v110, v125 row_ror:8 row_mask:0xf bank_mask:0x1
    v_add_f32_dpp v124, v107, v124 row_ror:4 row_mask:0xf bank_mask:0x1
    buffer_load_dwordx4 v[152:155], v1, s[16:19], s41 offen offset:1024 nt
    v_mfma_f32_16x16x32_bf16 v[96:99], v[172:175], v[8:11], 0
    v_mov_b32_dpp v120, v88 row_ror:4 row_mask:0xf bank_mask:0x2
    v_add_f32_dpp v127, v117, v127 row_ror:12 row_mask:0xf bank_mask:0x1
    v_add_f32_dpp v126, v114, v126 row_ror:8 row_mask:0xf bank_mask:0x1
    v_add_f32_dpp v125, v111, v125 row_ror:4 row_mask:0xf bank_mask:0x1
    s_waitcnt vmcnt(9)
    buffer_load_dwordx4 v[156:159], v1, s[16:19], s41 offen offset:2048 nt
    v_mfma_f32_16x16x32_bf16 v[100:103], v[176:179], v[8:11], 0
    v_mov_b32_dpp v121, v92 row_ror:4 row_mask:0xf bank_mask:0x2
    v_add_f32_dpp v120, v89, v120 quad_perm:[0,1,2,3] row_mask:0xf bank_mask:0x2
    v_add_f32_dpp v127, v118, v127 row_ror:8 row_mask:0xf bank_mask:0x1
    v_add_f32_dpp v126, v115, v126 row_ror:4 row_mask:0xf bank_mask:0x1
    buffer_load_dwordx4 v[160:163], v1, s[16:19], s41 offen offset:3072 nt
    s_add_u32 s41, s41, 12288
    s_and_b32 s41, s41, 524287
    v_mfma_f32_16x16x32_bf16 v[104:107], v[180:183], v[8:11], 0
    v_mov_b32_dpp v122, v96 row_ror:4 row_mask:0xf bank_mask:0x2
    v_add_f32_dpp v121, v93, v121 quad_perm:[0,1,2,3] row_mask:0xf bank_mask:0x2
    v_add_f32_dpp v120, v90, v120 row_ror:12 row_mask:0xf bank_mask:0x2
    v_add_f32_dpp v127, v119, v127 row_ror:4 row_mask:0xf bank_mask:0x1
    s_waitcnt vmcnt(9)
    buffer_load_dwordx4 v[164:167], v1, s[16:19], s41 offen offset:0 nt
    v_mfma_f32_16x16x32_bf16 v[108:111], v[184:187], v[8:11], 0
    v_mov_b32_dpp v123, v100 row_ror:4 row_mask:0xf bank_mask:0x2
    v_add_f32_dpp v122, v97, v122 quad_perm:[0,1,2,3] row_mask:0xf bank_mask:0x2
    v_add_f32_dpp v121, v94, v121 row_ror:12 row_mask:0xf bank_mask:0x2
    v_add_f32_dpp v120, v91, v120 row_ror:8 row_mask:0xf bank_mask:0x2
    buffer_load_dwordx4 v[168:171], v1, s[16:19], s41 offen offset:1024 nt
    v_mfma_f32_16x16x32_bf16 v[112:115], v[188:191], v[8:11], 0
    v_mov_b32_dpp v124, v104 row_ror:4 row_mask:0xf bank_mask:0x2
    v_add_f32_dpp v123, v101, v123 quad_perm:[0,1,2,3] row_mask:0xf bank_mask:0x2
    v_add_f32_dpp v122, v98, v122 row_ror:12 row_mask:0xf bank_mask:0x2
    v_add_f32_dpp v121, v95, v121 row_ror:8 row_mask:0xf bank_mask:0x2
    s_waitcnt vmcnt(9)
    buffer_load_dwordx4 v[172:175], v1, s[16:19], s41 offen offset:2048 nt
    v_mfma_f32_16x16x32_bf16 v[116:119], v[192:195], v[8:11], 0
    v_mov_b32_dpp v125, v108 row_ror:4 row_mask:0xf bank_mask:0x2
    v_add_f32_dpp v124, v105, v124 quad_perm:[0,1,2,3] row_mask:0xf bank_mask:0x2
    v_add_f32_dpp v123, v102, v123 row_ror:12 row_mask:0xf bank_mask:0x2
    v_add_f32_dpp v122, v99, v122 row_ror:8 row_mask:0xf bank_mask:0x2
    buffer_load_dwordx4 v[176:179], v1, s[16:19], s41 offen offset:3072 nt
    s_add_u32 s41, s41, 4096
    v_mfma_f32_16x16x32_bf16 v[88:91], v[132:135], v[8:11], 0
    v_mov_b32_dpp v126, v112 row_ror:4 row_mask:0xf bank_mask:0x2
    v_add_f32_dpp v125, v109, v125 quad_perm:[0,1,2,3] row_mask:0xf bank_mask:0x2
    v_add_f32_dpp v124, v106, v124 row_ror:12 row_mask:0xf bank_mask:0x2
    v_add_f32_dpp v123, v103, v123 row_ror:8 row_mask:0xf bank_mask:0x2
    s_waitcnt vmcnt(9)
    buffer_load_dwordx4 v[180:183], v1, s[16:19], s41 offen offset:0 nt
    v_mfma_f32_16x16x32_bf16 v[92:95], v[136:139], v[8:11], 0
    v_mov_b32_dpp v127, v116 row_ror:4 row_mask:0xf bank_mask:0x2
    v_add_f32_dpp v126, v113, v126 quad_perm:[0,1,2,3] row_mask:0xf bank_mask:0x2
    v_add_f32_dpp v125, v110, v125 row_ror:12 row_mask:0xf bank_mask:0x2
    v_add_f32_dpp v124, v107, v124 row_ror:8 row_mask:0xf bank_mask:0x2
    buffer_load_dwordx4 v[184:187], v1, s[16:19], s41 offen offset:1024 nt
    v_mfma_f32_16x16x32_bf16 v[96:99], v[140:143], v[8:11], 0
    v_mov_b32_dpp v120, v88 row_ror:8 row_mask:0xf bank_mask:0x4
    v_add_f32_dpp v127, v117, v127 quad_perm:[0,1,2,3] row_mask:0xf bank_mask:0x2
    v_add_f32_dpp v126, v114, v126 row_ror:12 row_mask:0xf bank_mask:0x2
    v_add_f32_dpp v125, v111, v125 row_ror:8 row_mask:0xf bank_mask:0x2
    s_waitcnt vmcnt(9)
    buffer_load_dwordx4 v[188:191], v1, s[16:19], s41 offen offset:2048 nt
    v_mfma_f32_16x16x32_bf16 v[100:103], v[144:147], v[8:11], 0
    v_mov_b32_dpp v121, v92 row_ror:8 row_mask:0xf bank_mask:0x4
    v_add_f32_dpp v120, v89, v120 row_ror:4 row_mask:0xf bank_mask:0x4
    v_add_f32_dpp v127, v118, v127 row_ror:12 row_mask:0xf bank_mask:0x2
    v_add_f32_dpp v126, v115, v126 row_ror:8 row_mask:0xf bank_mask:0x2
    buffer_load_dwordx4 v[192:195], v1, s[16:19], s41 offen offset:3072 nt
    s_add_u32 s41, s41, 12288
    s_and_b32 s41, s41, 524287
    v_mfma_f32_16x16x32_bf16 v[104:107], v[148:151], v[8:11], 0
    v_mov_b32_dpp v122, v96 row_ror:8 row_mask:0xf bank_mask:0x4
    v_add_f32_dpp v121, v93, v121 row_ror:4 row_mask:0xf bank_mask:0x4
    v_add_f32_dpp v120, v90, v120 quad_perm:[0,1,2,3] row_mask:0xf bank_mask:0x4
    v_add_f32_dpp v127, v119, v127 row_ror:8 row_mask:0xf bank_mask:0x2
    s_sub_u32 s60, s60, 1
    s_cbranch_scc1 L_done0
    s_waitcnt vmcnt(9)
    buffer_load_dwordx4 v[132:135], v1, s[16:19], s41 offen offset:0 nt
    v_mfma_f32_16x16x32_bf16 v[108:111], v[152:155], v[8:11], 0
    v_mov_b32_dpp v123, v100 row_ror:8 row_mask:0xf bank_mask:0x4
    v_add_f32_dpp v122, v97, v122 row_ror:4 row_mask:0xf bank_mask:0x4
    v_add_f32_dpp v121, v94, v121 quad_perm:[0,1,2,3] row_mask:0xf bank_mask:0x4
    v_add_f32_dpp v120, v91, v120 row_ror:12 row_mask:0xf bank_mask:0x4
    buffer_load_dwordx4 v[136:139], v1, s[16:19], s41 offen offset:1024 nt
    v_mfma_f32_16x16x32_bf16 v[112:115], v[156:159], v[8:11], 0
    v_mov_b32_dpp v124, v104 row_ror:8 row_mask:0xf bank_mask:0x4
    v_add_f32_dpp v123, v101, v123 row_ror:4 row_mask:0xf bank_mask:0x4
    v_add_f32_dpp v122, v98, v122 quad_perm:[0,1,2,3] row_mask:0xf bank_mask:0x4
    v_add_f32_dpp v121, v95, v121 row_ror:12 row_mask:0xf bank_mask:0x4
    s_waitcnt vmcnt(9)
    buffer_load_dwordx4 v[140:143], v1, s[16:19], s41 offen offset:2048 nt
    v_mfma_f32_16x16x32_bf16 v[116:119], v[160:163], v[8:11], 0
    v_mov_b32_dpp v125, v108 row_ror:8 row_mask:0xf bank_mask:0x4
    v_add_f32_dpp v124, v105, v124 row_ror:4 row_mask:0xf bank_mask:0x4
    v_add_f32_dpp v123, v102, v123 quad_perm:[0,1,2,3] row_mask:0xf bank_mask:0x4
    v_add_f32_dpp v122, v99, v122 row_ror:12 row_mask:0xf bank_mask:0x4
    buffer_load_dwordx4 v[144:147], v1, s[16:19], s41 offen offset:3072 nt
    s_add_u32 s41, s41, 4096
    v_mfma_f32_16x16x32_bf16 v[88:91], v[164:167], v[8:11], 0
    v_mov_b32_dpp v126, v112 row_ror:8 row_mask:0xf bank_mask:0x4
    v_add_f32_dpp v125, v109, v125 row_ror:4 row_mask:0xf bank_mask:0x4
    v_add_f32_dpp v124, v106, v124 quad_perm:[0,1,2,3] row_mask:0xf bank_mask:0x4
    v_add_f32_dpp v123, v103, v123 row_ror:12 row_mask:0xf bank_mask:0x4
    s_waitcnt vmcnt(9)
    buffer_load_dwordx4 v[148:151], v1, s[16:19], s41 offen offset:0 nt
    v_mfma_f32_16x16x32_bf16 v[92:95], v[168:171], v[8:11], 0
    v_mov_b32_dpp v127, v116 row_ror:8 row_mask:0xf bank_mask:0x4
    v_add_f32_dpp v126, v113, v126 row_ror:4 row_mask:0xf bank_mask:0x4
    v_add_f32_dpp v125, v110, v125 quad_perm:[0,1,2,3] row_mask:0xf bank_mask:0x4
    v_add_f32_dpp v124, v107, v124 row_ror:12 row_mask:0xf bank_mask:0x4
    buffer_load_dwordx4 v[152:155], v1, s[16:19], s41 offen offset:1024 nt
    v_mfma_f32_16x16x32_bf16 v[96:99], v[172:175], v[8:11], 0
    v_mov_b32_dpp v120, v88 row_ror:12 row_mask:0xf bank_mask:0x8
    v_add_f32_dpp v127, v117, v127 row_ror:4 row_mask:0xf bank_mask:0x4
    v_add_f32_dpp v126, v114, v126 quad_perm:[0,1,2,3] row_mask:0xf bank_mask:0x4
    v_add_f32_dpp v125, v111, v125 row_ror:12 row_mask:0xf bank_mask:0x4
    s_waitcnt vmcnt(9)
    buffer_load_dwordx4 v[156:159], v1, s[16:19], s41 offen offset:2048 nt
    v_mfma_f32_16x16x32_bf16 v[100:103], v[176:179], v[8:11], 0
    v_mov_b32_dpp v121, v92 row_ror:12 row_mask:0xf bank_mask:0x8
    v_add_f32_dpp v120, v89, v120 row_ror:8 row_mask:0xf bank_mask:0x8
    v_add_f32_dpp v127, v118, v127 quad_perm:[0,1,2,3] row_mask:0xf bank_mask:0x4
    v_add_f32_dpp v126, v115, v126 row_ror:12 row_mask:0xf bank_mask:0x4
    buffer_load_dwordx4 v[160:163], v1, s[16:19], s41 offen offset:3072 nt
    s_add_u32 s41, s41, 12288
    s_and_b32 s41, s41, 524287
    v_mfma_f32_16x16x32_bf16 v[104:107], v[180:183], v[8:11], 0
    v_mov_b32_dpp v122, v96 row_ror:12 row_mask:0xf bank_mask:0x8
    v_add_f32_dpp v121, v93, v121 row_ror:8 row_mask:0xf bank_mask:0x8
    v_add_f32_dpp v120, v90, v120 row_ror:4 row_mask:0xf bank_mask:0x8
    v_add_f32_dpp v127, v119, v127 row_ror:12 row_mask:0xf bank_mask:0x4
    s_waitcnt vmcnt(9)
    buffer_load_dwordx4 v[164:167], v1, s[16:19], s41 offen offset:0 nt
    v_mfma_f32_16x16x32_bf16 v[108:111], v[184:187], v[8:11], 0
    v_mov_b32_dpp v123, v100 row_ror:12 row_mask:0xf bank_mask:0x8
    v_add_f32_dpp v122, v97, v122 row_ror:8 row_mask:0xf bank_mask:0x8
    v_add_f32_dpp v121, v94, v121 row_ror:4 row_mask:0xf bank_mask:0x8
    v_add_f32_dpp v120, v91, v120 quad_perm:[0,1,2,3] row_mask:0xf bank_mask:0x8
    buffer_load_dwordx4 v[168:171], v1, s[16:19], s41 offen offset:1024 nt
    v_mfma_f32_16x16x32_bf16 v[112:115], v[188:191], v[8:11], 0
    v_mov_b32_dpp v124, v104 row_ror:12 row_mask:0xf bank_mask:0x8
    v_add_f32_dpp v123, v101, v123 row_ror:8 row_mask:0xf bank_mask:0x8
    v_add_f32_dpp v122, v98, v122 row_ror:4 row_mask:0xf bank_mask:0x8
    v_add_f32_dpp v121, v95, v121 quad_perm:[0,1,2,3] row_mask:0xf bank_mask:0x8
    v_max_f32 v6, v6, v120
    s_waitcnt vmcnt(9)
    buffer_load_dwordx4 v[172:175], v1, s[16:19], s41 offen offset:2048 nt
    v_mfma_f32_16x16x32_bf16 v[116:119], v[192:195], v[8:11], 0
    v_mov_b32_dpp v125, v108 row_ror:12 row_mask:0xf bank_mask:0x8
    v_add_f32_dpp v124, v105, v124 row_ror:8 row_mask:0xf bank_mask:0x8
    v_add_f32_dpp v123, v102, v123 row_ror:4 row_mask:0xf bank_mask:0x8
    v_add_f32_dpp v122, v99, v122 quad_perm:[0,1,2,3] row_mask:0xf bank_mask:0x8
    v_max_f32 v6, v6, v121
    buffer_load_dwordx4 v[176:179], v1, s[16:19], s41 offen offset:3072 nt
    s_add_u32 s41, s41, 4096
    v_mfma_f32_16x16x32_bf16 v[88:91], v[132:135], v[8:11], 0
    v_mov_b32_dpp v126, v112 row_ror:12 row_mask:0xf bank_mask:0x8
    v_add_f32_dpp v125, v109, v125 row_ror:8 row_mask:0xf bank_mask:0x8
    v_add_f32_dpp v124, v106, v124 row_ror:4 row_mask:0xf bank_mask:0x8
    v_add_f32_dpp v123, v103, v123 quad_perm:[0,1,2,3] row_mask:0xf bank_mask:0x8
    v_max_f32 v6, v6, v122
    s_waitcnt vmcnt(9)
    buffer_load_dwordx4 v[180:183], v1, s[16:19], s41 offen offset:0 nt
    v_mfma_f32_16x16x32_bf16 v[92:95], v[136:139], v[8:11], 0
    v_mov_b32_dpp v127, v116 row_ror:12 row_mask:0xf bank_mask:0x8
    v_add_f32_dpp v126, v113, v126 row_ror:8 row_mask:0xf bank_mask:0x8
    v_add_f32_dpp v125, v110, v125 row_ror:4 row_mask:0xf bank_mask:0x8
    v_add_f32_dpp v124, v107, v124 quad_perm:[0,1,2,3] row_mask:0xf bank_mask:0x8
    v_max_f32 v6, v6, v123
    ds_write_b128 v128, v[120:123] offset:3072
    buffer_load_dwordx4 v[184:187], v1, s[16:19], s41 offen offset:1024 nt
    v_mfma_f32_16x16x32_bf16 v[96:99], v[140:143], v[8:11], 0
    v_mov_b32_dpp v120, v88 quad_perm:[0,1,2,3] row_mask:0xf bank_mask:0x1
    v_add_f32_dpp v127, v117, v127 row_ror:8 row_mask:0xf bank_mask:0x8
    v_add_f32_dpp v126, v114, v126 row_ror:4 row_mask:0xf bank_mask:0x8
    v_add_f32_dpp v125, v111, v125 quad_perm:[0,1,2,3] row_mask:0xf bank_mask:0x8
    v_max_f32 v6, v6, v124
    s_waitcnt vmcnt(9)
    buffer_load_dwordx4 v[188:191], v1, s[16:19], s41 offen offset:2048 nt
    v_mfma_f32_16x16x32_bf16 v[100:103], v[144:147], v[8:11], 0
    v_mov_b32_dpp v121, v92 quad_perm:[0,1,2,3] row_mask:0xf bank_mask:0x1
    v_add_f32_dpp v120, v89, v120 row_ror:12 row_mask:0xf bank_mask:0x1
    v_add_f32_dpp v127, v118, v127 row_ror:4 row_mask:0xf bank_mask:0x8
    v_add_f32_dpp v126, v115, v126 quad_perm:[0,1,2,3] row_mask:0xf bank_mask:0x8
    v_max_f32 v6, v6, v125
    buffer_load_dwordx4 v[192:195], v1, s[16:19], s41 offen offset:3072 nt
    s_add_u32 s41, s41, 12288
    s_and_b32 s41, s41, 524287
    v_mfma_f32_16x16x32_bf16 v[104:107], v[148:151], v[8:11], 0
    v_mov_b32_dpp v122, v96 quad_perm:[0,1,2,3] row_mask:0xf bank_mask:0x1
    v_add_f32_dpp v121, v93, v121 row_ror:12 row_mask:0xf bank_mask:0x1
    v_add_f32_dpp v120, v90, v120 row_ror:8 row_mask:0xf bank_mask:0x1
    v_add_f32_dpp v127, v119, v127 quad_perm:[0,1,2,3] row_mask:0xf bank_mask:0x8
    v_max_f32 v6, v6, v126
    s_waitcnt vmcnt(9)
    buffer_load_dwordx4 v[132:135], v1, s[16:19], s41 offen offset:0 nt
    v_mfma_f32_16x16x32_bf16 v[108:111], v[152:155], v[8:11], 0
    v_mov_b32_dpp v123, v100 quad_perm:[0,1,2,3] row_mask:0xf bank_mask:0x1
    v_add_f32_dpp v122, v97, v122 row_ror:12 row_mask:0xf bank_mask:0x1
    v_add_f32_dpp v121, v94, v121 row_ror:8 row_mask:0xf bank_mask:0x1
    v_add_f32_dpp v120, v91, v120 row_ror:4 row_mask:0xf bank_mask:0x1
    v_max_f32 v6, v6, v127
    ds_write_b128 v128, v[124:127] offset:4096
    v_add_u32 v128, 2048, v128
    s_branch L_loop0
L_done0:
    s_waitcnt vmcnt(9)
    buffer_load_dwordx4 v[132:135], v2, s[20:23], s42 offen offset:0 nt
    v_mfma_f32_16x16x32_bf16 v[108:111], v[152:155], v[8:11], 0
    v_mov_b32_dpp v123, v100 row_ror:8 row_mask:0xf bank_mask:0x4
    v_add_f32_dpp v122, v97, v122 row_ror:4 row_mask:0xf bank_mask:0x4
    v_add_f32_dpp v121, v94, v121 quad_perm:[0,1,2,3] row_mask:0xf bank_mask:0x4
    v_add_f32_dpp v120, v91, v120 row_ror:12 row_mask:0xf bank_mask:0x4
    buffer_load_dwordx4 v[136:139], v2, s[20:23], s42 offen offset:1024 nt
    v_mfma_f32_16x16x32_bf16 v[112:115], v[156:159], v[8:11], 0
    v_mov_b32_dpp v124, v104 row_ror:8 row_mask:0xf bank_mask:0x4
    v_add_f32_dpp v123, v101, v123 row_ror:4 row_mask:0xf bank_mask:0x4
    v_add_f32_dpp v122, v98, v122 quad_perm:[0,1,2,3] row_mask:0xf bank_mask:0x4
    v_add_f32_dpp v121, v95, v121 row_ror:12 row_mask:0xf bank_mask:0x4
    s_waitcnt vmcnt(9)
    buffer_load_dwordx4 v[140:143], v2, s[20:23], s42 offen offset:2048 nt
    v_mfma_f32_16x16x32_bf16 v[116:119], v[160:163], v[8:11], 0
    v_mov_b32_dpp v125, v108 row_ror:8 row_mask:0xf bank_mask:0x4
    v_add_f32_dpp v124, v105, v124 row_ror:4 row_mask:0xf bank_mask:0x4
    v_add_f32_dpp v123, v102, v123 quad_perm:[0,1,2,3] row_mask:0xf bank_mask:0x4
    v_add_f32_dpp v122, v99, v122 row_ror:12 row_mask:0xf bank_mask:0x4
    buffer_load_dwordx4 v[144:147], v2, s[20:23], s42 offen offset:3072 nt
    s_add_u32 s42, s42, 4096
    v_mfma_f32_16x16x32_bf16 v[88:91], v[164:167], v[8:11], 0
    v_mov_b32_dpp v126, v112 row_ror:8 row_mask:0xf bank_mask:0x4
    v_add_f32_dpp v125, v109, v125 row_ror:4 row_mask:0xf bank_mask:0x4
    v_add_f32_dpp v124, v106, v124 quad_perm:[0,1,2,3] row_mask:0xf bank_mask:0x4
    v_add_f32_dpp v123, v103, v123 row_ror:12 row_mask:0xf bank_mask:0x4
    s_waitcnt vmcnt(9)
    buffer_load_dwordx4 v[148:151], v2, s[20:23], s42 offen offset:0 nt
    v_mfma_f32_16x16x32_bf16 v[92:95], v[168:171], v[8:11], 0
    v_mov_b32_dpp v127, v116 row_ror:8 row_mask:0xf bank_mask:0x4
    v_add_f32_dpp v126, v113, v126 row_ror:4 row_mask:0xf bank_mask:0x4
    v_add_f32_dpp v125, v110, v125 quad_perm:[0,1,2,3] row_mask:0xf bank_mask:0x4
    v_add_f32_dpp v124, v107, v124 row_ror:12 row_mask:0xf bank_mask:0x4
    buffer_load_dwordx4 v[152:155], v2, s[20:23], s42 offen offset:1024 nt
    v_mfma_f32_16x16x32_bf16 v[96:99], v[172:175], v[8:11], 0
    v_mov_b32_dpp v120, v88 row_ror:12 row_mask:0xf bank_mask:0x8
    v_add_f32_dpp v127, v117, v127 row_ror:4 row_mask:0xf bank_mask:0x4
    v_add_f32_dpp v126, v114, v126 quad_perm:[0,1,2,3] row_mask:0xf bank_mask:0x4
    v_add_f32_dpp v125, v111, v125 row_ror:12 row_mask:0xf bank_mask:0x4
    s_waitcnt vmcnt(9)
    buffer_load_dwordx4 v[156:159], v2, s[20:23], s42 offen offset:2048 nt
    v_mfma_f32_16x16x32_bf16 v[100:103], v[176:179], v[8:11], 0
    v_mov_b32_dpp v121, v92 row_ror:12 row_mask:0xf bank_mask:0x8
    v_add_f32_dpp v120, v89, v120 row_ror:8 row_mask:0xf bank_mask:0x8
    v_add_f32_dpp v127, v118, v127 quad_perm:[0,1,2,3] row_mask:0xf bank_mask:0x4
    v_add_f32_dpp v126, v115, v126 row_ror:12 row_mask:0xf bank_mask:0x4
    buffer_load_dwordx4 v[160:163], v2, s[20:23], s42 offen offset:3072 nt
    s_add_u32 s42, s42, 12288
    s_and_b32 s42, s42, 524287
    v_mfma_f32_16x16x32_bf16 v[104:107], v[180:183], v[8:11], 0
    v_mov_b32_dpp v122, v96 row_ror:12 row_mask:0xf bank_mask:0x8
    v_add_f32_dpp v121, v93, v121 row_ror:8 row_mask:0xf bank_mask:0x8
    v_add_f32_dpp v120, v90, v120 row_ror:4 row_mask:0xf bank_mask:0x8
    v_add_f32_dpp v127, v119, v127 row_ror:12 row_mask:0xf bank_mask:0x4
    s_waitcnt vmcnt(9)
    buffer_load_dwordx4 v[164:167], v2, s[20:23], s42 offen offset:0 nt
    v_mfma_f32_16x16x32_bf16 v[108:111], v[184:187], v[8:11], 0
    v_mov_b32_dpp v123, v100 row_ror:12 row_mask:0xf bank_mask:0x8
    v_add_f32_dpp v122, v97, v122 row_ror:8 row_mask:0xf bank_mask:0x8
    v_add_f32_dpp v121, v94, v121 row_ror:4 row_mask:0xf bank_mask:0x8
    v_add_f32_dpp v120, v91, v120 quad_perm:[0,1,2,3] row_mask:0xf bank_mask:0x8
    buffer_load_dwordx4 v[168:171], v2, s[20:23], s42 offen offset:1024 nt
    v_mfma_f32_16x16x32_bf16 v[112:115], v[188:191], v[8:11], 0
    v_mov_b32_dpp v124, v104 row_ror:12 row_mask:0xf bank_mask:0x8
    v_add_f32_dpp v123, v101, v123 row_ror:8 row_mask:0xf bank_mask:0x8
    v_add_f32_dpp v122, v98, v122 row_ror:4 row_mask:0xf bank_mask:0x8
    v_add_f32_dpp v121, v95, v121 quad_perm:[0,1,2,3] row_mask:0xf bank_mask:0x8
    v_max_f32 v6, v6, v120
    s_waitcnt vmcnt(9)
    buffer_load_dwordx4 v[172:175], v2, s[20:23], s42 offen offset:2048 nt
    v_mfma_f32_16x16x32_bf16 v[116:119], v[192:195], v[8:11], 0
    v_mov_b32_dpp v125, v108 row_ror:12 row_mask:0xf bank_mask:0x8
    v_add_f32_dpp v124, v105, v124 row_ror:8 row_mask:0xf bank_mask:0x8
    v_add_f32_dpp v123, v102, v123 row_ror:4 row_mask:0xf bank_mask:0x8
    v_add_f32_dpp v122, v99, v122 quad_perm:[0,1,2,3] row_mask:0xf bank_mask:0x8
    v_max_f32 v6, v6, v121
    buffer_load_dwordx4 v[176:179], v2, s[20:23], s42 offen offset:3072 nt
    s_add_u32 s42, s42, 4096
    v_mov_b32_dpp v126, v112 row_ror:12 row_mask:0xf bank_mask:0x8
    v_add_f32_dpp v125, v109, v125 row_ror:8 row_mask:0xf bank_mask:0x8
    v_add_f32_dpp v124, v106, v124 row_ror:4 row_mask:0xf bank_mask:0x8
    v_add_f32_dpp v123, v103, v123 quad_perm:[0,1,2,3] row_mask:0xf bank_mask:0x8
    v_max_f32 v6, v6, v122
    s_waitcnt vmcnt(9)
    buffer_load_dwordx4 v[180:183], v2, s[20:23], s42 offen offset:0 nt
    v_mov_b32_dpp v127, v116 row_ror:12 row_mask:0xf bank_mask:0x8
    v_add_f32_dpp v126, v113, v126 row_ror:8 row_mask:0xf bank_mask:0x8
    v_add_f32_dpp v125, v110, v125 row_ror:4 row_mask:0xf bank_mask:0x8
    v_add_f32_dpp v124, v107, v124 quad_perm:[0,1,2,3] row_mask:0xf bank_mask:0x8
    v_max_f32 v6, v6, v123
    ds_write_b128 v128, v[120:123] offset:3072
    v_perm_b32 v24, v136, v132, s43
    v_perm_b32 v32, v137, v133, s43
    v_perm_b32 v40, v138, v134, s43
    v_perm_b32 v48, v139, v135, s43
    buffer_load_dwordx4 v[184:187], v2, s[20:23], s42 offen offset:1024 nt
    v_add_f32_dpp v127, v117, v127 row_ror:8 row_mask:0xf bank_mask:0x8
    v_add_f32_dpp v126, v114, v126 row_ror:4 row_mask:0xf bank_mask:0x8
    v_add_f32_dpp v125, v111, v125 quad_perm:[0,1,2,3] row_mask:0xf bank_mask:0x8
    v_max_f32 v6, v6, v124
    v_perm_b32 v28, v136, v132, s44
    v_perm_b32 v36, v137, v133, s44
    v_perm_b32 v44, v138, v134, s44
    v_perm_b32 v52, v139, v135, s44
    s_waitcnt vmcnt(9)
    buffer_load_dwordx4 v[188:191], v2, s[20:23], s42 offen offset:2048 nt
    v_add_f32_dpp v127, v118, v127 row_ror:4 row_mask:0xf bank_mask:0x8
    v_add_f32_dpp v126, v115, v126 quad_perm:[0,1,2,3] row_mask:0xf bank_mask:0x8
    v_max_f32 v6, v6, v125
    v_perm_b32 v25, v144, v140, s43
    v_perm_b32 v33, v145, v141, s43
    v_perm_b32 v41, v146, v142, s43
    v_perm_b32 v49, v147, v143, s43
    buffer_load_dwordx4 v[192:195], v2, s[20:23], s42 offen offset:3072 nt
    s_add_u32 s42, s42, 12288
    s_and_b32 s42, s42, 524287
    v_add_f32_dpp v127, v119, v127 quad_perm:[0,1,2,3] row_mask:0xf bank_mask:0x8
    v_max_f32 v6, v6, v126
    v_perm_b32 v29, v144, v140, s44
    v_perm_b32 v37, v145, v141, s44
    v_perm_b32 v45, v146, v142, s44
    v_perm_b32 v53, v147, v143, s44
    s_waitcnt vmcnt(9)
    buffer_load_dwordx4 v[132:135], v2, s[20:23], s42 offen offset:0 nt
    v_max_f32 v6, v6, v127
    ds_write_b128 v128, v[124:127] offset:4096
    v_add_u32 v128, 2048, v128
    v_perm_b32 v26, v152, v148, s43
    v_perm_b32 v34, v153, v149, s43
    v_perm_b32 v42, v154, v150, s43
    v_perm_b32 v50, v155, v151, s43
    ds_read_b128 v[120:123], v129 offset:3072
    ds_read_b128 v[124:127], v129 offset:4096
    v_add_u32 v129, 2048, v129
    v_max_f32_dpp v6, v6, v6 row_ror:4 row_mask:0xf bank_mask:0xf
    buffer_load_dwordx4 v[136:139], v2, s[20:23], s42 offen offset:1024 nt
    v_perm_b32 v30, v152, v148, s44
    v_perm_b32 v38, v153, v149, s44
    v_perm_b32 v46, v154, v150, s44
    v_perm_b32 v54, v155, v151, s44
    v_max_f32_dpp v6, v6, v6 row_ror:8 row_mask:0xf bank_mask:0xf
    v_mov_b32 v3, v6
    s_nop 1
    v_permlane32_swap_b32 v3, v6
    s_nop 0
    v_max_f32 v6, v3, v6
    v_mov_b32 v3, v6
    s_waitcnt vmcnt(9)
    buffer_load_dwordx4 v[140:143], v2, s[20:23], s42 offen offset:2048 nt
    v_perm_b32 v27, v160, v156, s43
    v_perm_b32 v35, v161, v157, s43
    v_perm_b32 v43, v162, v158, s43
    v_perm_b32 v51, v163, v159, s43
    v_permlane16_swap_b32 v3, v6
    s_nop 0
    v_max_f32 v6, v3, v6
    v_mul_f32 v6, s45, v6
    buffer_load_dwordx4 v[144:147], v2, s[20:23], s42 offen offset:3072 nt
    s_add_u32 s42, s42, 4096
    v_perm_b32 v31, v160, v156, s44
    v_perm_b32 v39, v161, v157, s44
    v_perm_b32 v47, v162, v158, s44
    v_perm_b32 v55, v163, v159, s44
    s_waitcnt lgkmcnt(0)
    v_fma_f32 v120, v120, s45, -v6
    v_fma_f32 v121, v121, s45, -v6
    v_fma_f32 v122, v122, s45, -v6
    v_fma_f32 v123, v123, s45, -v6
    v_fma_f32 v124, v124, s45, -v6
    v_fma_f32 v125, v125, s45, -v6
    v_fma_f32 v126, v126, s45, -v6
    v_fma_f32 v127, v127, s45, -v6
    s_waitcnt vmcnt(9)
    buffer_load_dwordx4 v[148:151], v2, s[20:23], s42 offen offset:0 nt
    v_perm_b32 v56, v168, v164, s43
    v_perm_b32 v64, v169, v165, s43
    v_perm_b32 v72, v170, v166, s43
    v_perm_b32 v80, v171, v167, s43
    v_exp_f32 v120, v120
    v_exp_f32 v121, v121
    v_exp_f32 v122, v122
    v_exp_f32 v123, v123
    buffer_load_dwordx4 v[152:155], v2, s[20:23], s42 offen offset:1024 nt
    v_perm_b32 v60, v168, v164, s44
    v_perm_b32 v68, v169, v165, s44
    v_perm_b32 v76, v170, v166, s44
    v_perm_b32 v84, v171, v167, s44
    v_exp_f32 v124, v124
    v_exp_f32 v125, v125
    v_exp_f32 v126, v126
    v_exp_f32 v127, v127
    s_waitcnt vmcnt(9)
    buffer_load_dwordx4 v[156:159], v2, s[20:23], s42 offen offset:2048 nt
    v_perm_b32 v57, v176, v172, s43
    v_perm_b32 v65, v177, v173, s43
    v_perm_b32 v73, v178, v174, s43
    v_perm_b32 v81, v179, v175, s43
    v_cvt_pk_bf16_f32 v12, v120, v121
    v_cvt_pk_bf16_f32 v13, v122, v123
    v_cvt_pk_bf16_f32 v14, v124, v125
    v_cvt_pk_bf16_f32 v15, v126, v127
    v_cndmask_b32 v16, 0, v12, s[46:47]
    v_cndmask_b32 v17, 0, v13, s[46:47]
    v_cndmask_b32 v18, 0, v14, s[46:47]
    v_cndmask_b32 v19, 0, v15, s[46:47]
    buffer_load_dwordx4 v[160:163], v2, s[20:23], s42 offen offset:3072 nt
    s_add_u32 s42, s42, 12288
    s_and_b32 s42, s42, 524287
    v_perm_b32 v61, v176, v172, s44
    v_perm_b32 v69, v177, v173, s44
    v_perm_b32 v77, v178, v174, s44
    v_perm_b32 v85, v179, v175, s44
    v_mfma_f32_16x16x32_bf16 v[88:91], v[16:19], v[24:27], 0
    v_mfma_f32_16x16x32_bf16 v[96:99], v[16:19], v[32:35], 0
    s_waitcnt vmcnt(9)
    buffer_load_dwordx4 v[164:167], v2, s[20:23], s42 offen offset:0 nt
    v_perm_b32 v58, v184, v180, s43
    v_perm_b32 v66, v185, v181, s43
    v_perm_b32 v74, v186, v182, s43
    v_perm_b32 v82, v187, v183, s43
    v_mfma_f32_16x16x32_bf16 v[104:107], v[16:19], v[40:43], 0
    v_mfma_f32_16x16x32_bf16 v[112:115], v[16:19], v[48:51], 0
    buffer_load_dwordx4 v[168:171], v2, s[20:23], s42 offen offset:1024 nt
    v_perm_b32 v62, v184, v180, s44
    v_perm_b32 v70, v185, v181, s44
    v_perm_b32 v78, v186, v182, s44
    v_perm_b32 v86, v187, v183, s44
    v_mfma_f32_16x16x32_bf16 v[92:95], v[16:19], v[28:31], 0
    v_mfma_f32_16x16x32_bf16 v[100:103], v[16:19], v[36:39], 0
    s_waitcnt vmcnt(9)
    buffer_load_dwordx4 v[172:175], v2, s[20:23], s42 offen offset:2048 nt
    v_perm_b32 v59, v192, v188, s43
    v_perm_b32 v67, v193, v189, s43
    v_perm_b32 v75, v194, v190, s43
    v_perm_b32 v83, v195, v191, s43
    v_mfma_f32_16x16x32_bf16 v[108:111], v[16:19], v[44:47], 0
    v_mfma_f32_16x16x32_bf16 v[116:119], v[16:19], v[52:55], 0
    buffer_load_dwordx4 v[176:179], v2, s[20:23], s42 offen offset:3072 nt
    s_add_u32 s42, s42, 4096
    v_perm_b32 v63, v192, v188, s44
    v_perm_b32 v71, v193, v189, s44
    v_perm_b32 v79, v194, v190, s44
    v_perm_b32 v87, v195, v191, s44
    v_cndmask_b32 v20, 0, v12, s[48:49]
    v_cndmask_b32 v21, 0, v13, s[48:49]
    v_cndmask_b32 v22, 0, v14, s[48:49]
    v_cndmask_b32 v23, 0, v15, s[48:49]
    v_add_f32 v120, v120, v121
    v_add_f32 v122, v122, v123
    v_add_f32 v124, v124, v125
    v_add_f32 v126, v126, v127
    s_waitcnt vmcnt(9)
    buffer_load_dwordx4 v[180:183], v2, s[20:23], s42 offen offset:0 nt
    v_perm_b32 v24, v136, v132, s43
    v_perm_b32 v32, v137, v133, s43
    v_perm_b32 v40, v138, v134, s43
    v_perm_b32 v48, v139, v135, s43
    v_add_f32 v120, v120, v122
    v_add_f32 v124, v124, v126
    v_add_f32 v120, v120, v124
    v_add_f32 v7, v7, v120
    ds_read_b128 v[120:123], v129 offset:3072
    ds_read_b128 v[124:127], v129 offset:4096
    v_add_u32 v129, 2048, v129
    buffer_load_dwordx4 v[184:187], v2, s[20:23], s42 offen offset:1024 nt
    v_perm_b32 v28, v136, v132, s44
    v_perm_b32 v36, v137, v133, s44
    v_perm_b32 v44, v138, v134, s44
    v_perm_b32 v52, v139, v135, s44
    v_mfma_f32_16x16x32_bf16 v[88:91], v[20:23], v[56:59], v[88:91]
    v_mfma_f32_16x16x32_bf16 v[96:99], v[20:23], v[64:67], v[96:99]
    s_waitcnt vmcnt(9)
    buffer_load_dwordx4 v[188:191], v2, s[20:23], s42 offen offset:2048 nt
    v_perm_b32 v25, v144, v140, s43
    v_perm_b32 v33, v145, v141, s43
    v_perm_b32 v41, v146, v142, s43
    v_perm_b32 v49, v147, v143, s43
    v_mfma_f32_16x16x32_bf16 v[104:107], v[20:23], v[72:75], v[104:107]
    v_mfma_f32_16x16x32_bf16 v[112:115], v[20:23], v[80:83], v[112:115]
    buffer_load_dwordx4 v[192:195], v2, s[20:23], s42 offen offset:3072 nt
    s_add_u32 s42, s42, 12288
    s_and_b32 s42, s42, 524287
    v_perm_b32 v29, v144, v140, s44
    v_perm_b32 v37, v145, v141, s44
    v_perm_b32 v45, v146, v142, s44
    v_perm_b32 v53, v147, v143, s44
    v_mfma_f32_16x16x32_bf16 v[92:95], v[20:23], v[60:63], v[92:95]
    v_mfma_f32_16x16x32_bf16 v[100:103], v[20:23], v[68:71], v[100:103]
    s_waitcnt vmcnt(9)
    buffer_load_dwordx4 v[132:135], v2, s[20:23], s42 offen offset:0 nt
    v_perm_b32 v26, v152, v148, s43
    v_perm_b32 v34, v153, v149, s43
    v_perm_b32 v42, v154, v150, s43
    v_perm_b32 v50, v155, v151, s43
    v_mfma_f32_16x16x32_bf16 v[108:111], v[20:23], v[76:79], v[108:111]
    v_mfma_f32_16x16x32_bf16 v[116:119], v[20:23], v[84:87], v[116:119]
    buffer_load_dwordx4 v[136:139], v2, s[20:23], s42 offen offset:1024 nt
    v_perm_b32 v30, v152, v148, s44
    v_perm_b32 v38, v153, v149, s44
    v_perm_b32 v46, v154, v150, s44
    v_perm_b32 v54, v155, v151, s44
    v_cndmask_b32 v16, 0, v12, s[50:51]
    v_cndmask_b32 v17, 0, v13, s[50:51]
    v_cndmask_b32 v18, 0, v14, s[50:51]
    v_cndmask_b32 v19, 0, v15, s[50:51]
    s_waitcnt lgkmcnt(0)
    v_fma_f32 v120, v120, s45, -v6
    v_fma_f32 v121, v121, s45, -v6
    v_fma_f32 v122, v122, s45, -v6
    v_fma_f32 v123, v123, s45, -v6
    s_waitcnt vmcnt(9)
    buffer_load_dwordx4 v[140:143], v2, s[20:23], s42 offen offset:2048 nt
    v_perm_b32 v27, v160, v156, s43
    v_perm_b32 v35, v161, v157, s43
    v_perm_b32 v43, v162, v158, s43
    v_perm_b32 v51, v163, v159, s43
    v_fma_f32 v124, v124, s45, -v6
    v_fma_f32 v125, v125, s45, -v6
    v_fma_f32 v126, v126, s45, -v6
    v_fma_f32 v127, v127, s45, -v6
    v_exp_f32 v120, v120
    v_exp_f32 v121, v121
    buffer_load_dwordx4 v[144:147], v2, s[20:23], s42 offen offset:3072 nt
    s_add_u32 s42, s42, 4096
    v_perm_b32 v31, v160, v156, s44
    v_perm_b32 v39, v161, v157, s44
    v_perm_b32 v47, v162, v158, s44
    v_perm_b32 v55, v163, v159, s44
    v_mfma_f32_16x16x32_bf16 v[88:91], v[16:19], v[24:27], v[88:91]
    v_mfma_f32_16x16x32_bf16 v[96:99], v[16:19], v[32:35], v[96:99]
    s_waitcnt vmcnt(9)
    buffer_load_dwordx4 v[148:151], v2, s[20:23], s42 offen offset:0 nt
    v_perm_b32 v56, v168, v164, s43
    v_perm_b32 v64, v169, v165, s43
    v_perm_b32 v72, v170, v166, s43
    v_perm_b32 v80, v171, v167, s43
    v_mfma_f32_16x16x32_bf16 v[104:107], v[16:19], v[40:43], v[104:107]
    v_mfma_f32_16x16x32_bf16 v[112:115], v[16:19], v[48:51], v[112:115]
    buffer_load_dwordx4 v[152:155], v2, s[20:23], s42 offen offset:1024 nt
    v_perm_b32 v60, v168, v164, s44
    v_perm_b32 v68, v169, v165, s44
    v_perm_b32 v76, v170, v166, s44
    v_perm_b32 v84, v171, v167, s44
    v_mfma_f32_16x16x32_bf16 v[92:95], v[16:19], v[28:31], v[92:95]
    v_mfma_f32_16x16x32_bf16 v[100:103], v[16:19], v[36:39], v[100:103]
    s_waitcnt vmcnt(9)
    buffer_load_dwordx4 v[156:159], v2, s[20:23], s42 offen offset:2048 nt
    v_perm_b32 v57, v176, v172, s43
    v_perm_b32 v65, v177, v173, s43
    v_perm_b32 v73, v178, v174, s43
    v_perm_b32 v81, v179, v175, s43
    v_mfma_f32_16x16x32_bf16 v[108:111], v[16:19], v[44:47], v[108:111]
    v_mfma_f32_16x16x32_bf16 v[116:119], v[16:19], v[52:55], v[116:119]
    buffer_load_dwordx4 v[160:163], v2, s[20:23], s42 offen offset:3072 nt
    s_add_u32 s42, s42, 12288
    s_and_b32 s42, s42, 524287
    v_perm_b32 v61, v176, v172, s44
    v_perm_b32 v69, v177, v173, s44
    v_perm_b32 v77, v178, v174, s44
    v_perm_b32 v85, v179, v175, s44
    v_cndmask_b32 v20, 0, v12, s[52:53]
    v_cndmask_b32 v21, 0, v13, s[52:53]
    v_cndmask_b32 v22, 0, v14, s[52:53]
    v_cndmask_b32 v23, 0, v15, s[52:53]
    v_exp_f32 v122, v122
    v_exp_f32 v123, v123
    s_waitcnt vmcnt(9)
    buffer_load_dwordx4 v[164:167], v2, s[20:23], s42 offen offset:0 nt
    v_perm_b32 v58, v184, v180, s43
    v_perm_b32 v66, v185, v181, s43
    v_perm_b32 v74, v186, v182, s43
    v_perm_b32 v82, v187, v183, s43
    v_exp_f32 v124, v124
    v_exp_f32 v125, v125
    v_exp_f32 v126, v126
    v_exp_f32 v127, v127
    s_mov_b32 s60, 6
L_loop1:
    buffer_load_dwordx4 v[168:171], v2, s[20:23], s42 offen offset:1024 nt
    v_perm_b32 v62, v184, v180, s44
    v_perm_b32 v70, v185, v181, s44
    v_perm_b32 v78, v186, v182, s44
    v_perm_b32 v86, v187, v183, s44
    s_waitcnt vmcnt(9)
    buffer_load_dwordx4 v[172:175], v2, s[20:23], s42 offen offset:2048 nt
    v_perm_b32 v59, v192, v188, s43
    v_perm_b32 v67, v193, v189, s43
    v_perm_b32 v75, v194, v190, s43
    v_perm_b32 v83, v195, v191, s43
    v_mfma_f32_16x16x32_bf16 v[88:91], v[20:23], v[56:59], v[88:91]
    v_mfma_f32_16x16x32_bf16 v[96:99], v[20:23], v[64:67], v[96:99]
    buffer_load_dwordx4 v[176:179], v2, s[20:23], s42 offen offset:3072 nt
    s_add_u32 s42, s42, 4096
    v_perm_b32 v63, v192, v188, s44
    v_perm_b32 v71, v193, v189, s44
    v_perm_b32 v79, v194, v190, s44
    v_perm_b32 v87, v195, v191, s44
    v_mfma_f32_16x16x32_bf16 v[104:107], v[20:23], v[72:75], v[104:107]
    v_mfma_f32_16x16x32_bf16 v[112:115], v[20:23], v[80:83], v[112:115]
    s_waitcnt vmcnt(9)
    buffer_load_dwordx4 v[180:183], v2, s[20:23], s42 offen offset:0 nt
    v_perm_b32 v24, v136, v132, s43
    v_perm_b32 v32, v137, v133, s43
    v_perm_b32 v40, v138, v134, s43
    v_perm_b32 v48, v139, v135, s43
    v_mfma_f32_16x16x32_bf16 v[92:95], v[20:23], v[60:63], v[92:95]
    v_mfma_f32_16x16x32_bf16 v[100:103], v[20:23], v[68:71], v[100:103]
    buffer_load_dwordx4 v[184:187], v2, s[20:23], s42 offen offset:1024 nt
    v_perm_b32 v28, v136, v132, s44
    v_perm_b32 v36, v137, v133, s44
    v_perm_b32 v44, v138, v134, s44
    v_perm_b32 v52, v139, v135, s44
    v_mfma_f32_16x16x32_bf16 v[108:111], v[20:23], v[76:79], v[108:111]
    v_mfma_f32_16x16x32_bf16 v[116:119], v[20:23], v[84:87], v[116:119]
    s_waitcnt vmcnt(9)
    buffer_load_dwordx4 v[188:191], v2, s[20:23], s42 offen offset:2048 nt
    v_perm_b32 v25, v144, v140, s43
    v_perm_b32 v33, v145, v141, s43
    v_perm_b32 v41, v146, v142, s43
    v_perm_b32 v49, v147, v143, s43
    v_cvt_pk_bf16_f32 v12, v120, v121
    v_cvt_pk_bf16_f32 v13, v122, v123
    v_cvt_pk_bf16_f32 v14, v124, v125
    v_cvt_pk_bf16_f32 v15, v126, v127
    v_cndmask_b32 v16, 0, v12, s[46:47]
    v_cndmask_b32 v17, 0, v13, s[46:47]
    v_cndmask_b32 v18, 0, v14, s[46:47]
    v_cndmask_b32 v19, 0, v15, s[46:47]
    buffer_load_dwordx4 v[192:195], v2, s[20:23], s42 offen offset:3072 nt
    s_add_u32 s42, s42, 12288
    s_and_b32 s42, s42, 524287
    v_perm_b32 v29, v144, v140, s44
    v_perm_b32 v37, v145, v141, s44
    v_perm_b32 v45, v146, v142, s44
    v_perm_b32 v53, v147, v143, s44
    s_waitcnt vmcnt(9)
    buffer_load_dwordx4 v[132:135], v2, s[20:23], s42 offen offset:0 nt
    v_perm_b32 v26, v152, v148, s43
    v_perm_b32 v34, v153, v149, s43
    v_perm_b32 v42, v154, v150, s43
    v_perm_b32 v50, v155, v151, s43
    buffer_load_dwordx4 v[136:139], v2, s[20:23], s42 offen offset:1024 nt
    v_perm_b32 v30, v152, v148, s44
    v_perm_b32 v38, v153, v149, s44
    v_perm_b32 v46, v154, v150, s44
    v_perm_b32 v54, v155, v151, s44
    s_waitcnt vmcnt(9)
    buffer_load_dwordx4 v[140:143], v2, s[20:23], s42 offen offset:2048 nt
    v_perm_b32 v27, v160, v156, s43
    v_perm_b32 v35, v161, v157, s43
    v_perm_b32 v43, v162, v158, s43
    v_perm_b32 v51, v163, v159, s43
    v_mfma_f32_16x16x32_bf16 v[88:91], v[16:19], v[24:27], v[88:91]
    v_mfma_f32_16x16x32_bf16 v[96:99], v[16:19], v[32:35], v[96:99]
    buffer_load_dwordx4 v[144:147], v2, s[20:23], s42 offen offset:3072 nt
    s_add_u32 s42, s42, 4096
    v_perm_b32 v31, v160, v156, s44
    v_perm_b32 v39, v161, v157, s44
    v_perm_b32 v47, v162, v158, s44
    v_perm_b32 v55, v163, v159, s44
    v_mfma_f32_16x16x32_bf16 v[104:107], v[16:19], v[40:43], v[104:107]
    v_mfma_f32_16x16x32_bf16 v[112:115], v[16:19], v[48:51], v[112:115]
    s_waitcnt vmcnt(9)
    buffer_load_dwordx4 v[148:151], v2, s[20:23], s42 offen offset:0 nt
    v_perm_b32 v56, v168, v164, s43
    v_perm_b32 v64, v169, v165, s43
    v_perm_b32 v72, v170, v166, s43
    v_perm_b32 v80, v171, v167, s43
    v_mfma_f32_16x16x32_bf16 v[92:95], v[16:19], v[28:31], v[92:95]
    v_mfma_f32_16x16x32_bf16 v[100:103], v[16:19], v[36:39], v[100:103]
    buffer_load_dwordx4 v[152:155], v2, s[20:23], s42 offen offset:1024 nt
    v_perm_b32 v60, v168, v164, s44
    v_perm_b32 v68, v169, v165, s44
    v_perm_b32 v76, v170, v166, s44
    v_perm_b32 v84, v171, v167, s44
    v_mfma_f32_16x16x32_bf16 v[108:111], v[16:19], v[44:47], v[108:111]
    v_mfma_f32_16x16x32_bf16 v[116:119], v[16:19], v[52:55], v[116:119]
    s_waitcnt vmcnt(9)
    buffer_load_dwordx4 v[156:159], v2, s[20:23], s42 offen offset:2048 nt
    v_perm_b32 v57, v176, v172, s43
    v_perm_b32 v65, v177, v173, s43
    v_perm_b32 v73, v178, v174, s43
    v_perm_b32 v81, v179, v175, s43
    v_cndmask_b32 v20, 0, v12, s[48:49]
    v_cndmask_b32 v21, 0, v13, s[48:49]
    v_cndmask_b32 v22, 0, v14, s[48:49]
    v_cndmask_b32 v23, 0, v15, s[48:49]
    v_add_f32 v120, v120, v121
    v_add_f32 v122, v122, v123
    v_add_f32 v124, v124, v125
    v_add_f32 v126, v126, v127
    s_sub_u32 s60, s60, 1
    s_cbranch_scc1 L_done1
    buffer_load_dwordx4 v[160:163], v2, s[20:23], s42 offen offset:3072 nt
    s_add_u32 s42, s42, 12288
    s_and_b32 s42, s42, 524287
    v_perm_b32 v61, v176, v172, s44
    v_perm_b32 v69, v177, v173, s44
    v_perm_b32 v77, v178, v174, s44
    v_perm_b32 v85, v179, v175, s44
    v_add_f32 v120, v120, v122
    v_add_f32 v124, v124, v126
    v_add_f32 v120, v120, v124
    v_add_f32 v7, v7, v120
    ds_read_b128 v[120:123], v129 offset:3072
    ds_read_b128 v[124:127], v129 offset:4096
    v_add_u32 v129, 2048, v129
    s_waitcnt vmcnt(9)
    buffer_load_dwordx4 v[164:167], v2, s[20:23], s42 offen offset:0 nt
    v_perm_b32 v58, v184, v180, s43
    v_perm_b32 v66, v185, v181, s43
    v_perm_b32 v74, v186, v182, s43
    v_perm_b32 v82, v187, v183, s43
    buffer_load_dwordx4 v[168:171], v2, s[20:23], s42 offen offset:1024 nt
    v_perm_b32 v62, v184, v180, s44
    v_perm_b32 v70, v185, v181, s44
    v_perm_b32 v78, v186, v182, s44
    v_perm_b32 v86, v187, v183, s44
    s_waitcnt vmcnt(9)
    buffer_load_dwordx4 v[172:175], v2, s[20:23], s42 offen offset:2048 nt
    v_perm_b32 v59, v192, v188, s43
    v_perm_b32 v67, v193, v189, s43
    v_perm_b32 v75, v194, v190, s43
    v_perm_b32 v83, v195, v191, s43
    v_mfma_f32_16x16x32_bf16 v[88:91], v[20:23], v[56:59], v[88:91]
    v_mfma_f32_16x16x32_bf16 v[96:99], v[20:23], v[64:67], v[96:99]
    buffer_load_dwordx4 v[176:179], v2, s[20:23], s42 offen offset:3072 nt
    s_add_u32 s42, s42, 4096
    v_perm_b32 v63, v192, v188, s44
    v_perm_b32 v71, v193, v189, s44
    v_perm_b32 v79, v194, v190, s44
    v_perm_b32 v87, v195, v191, s44
    v_mfma_f32_16x16x32_bf16 v[104:107], v[20:23], v[72:75], v[104:107]
    v_mfma_f32_16x16x32_bf16 v[112:115], v[20:23], v[80:83], v[112:115]
    s_waitcnt vmcnt(9)
    buffer_load_dwordx4 v[180:183], v2, s[20:23], s42 offen offset:0 nt
    v_perm_b32 v24, v136, v132, s43
    v_perm_b32 v32, v137, v133, s43
    v_perm_b32 v40, v138, v134, s43
    v_perm_b32 v48, v139, v135, s43
    v_mfma_f32_16x16x32_bf16 v[92:95], v[20:23], v[60:63], v[92:95]
    v_mfma_f32_16x16x32_bf16 v[100:103], v[20:23], v[68:71], v[100:103]
    buffer_load_dwordx4 v[184:187], v2, s[20:23], s42 offen offset:1024 nt
    v_perm_b32 v28, v136, v132, s44
    v_perm_b32 v36, v137, v133, s44
    v_perm_b32 v44, v138, v134, s44
    v_perm_b32 v52, v139, v135, s44
    v_mfma_f32_16x16x32_bf16 v[108:111], v[20:23], v[76:79], v[108:111]
    v_mfma_f32_16x16x32_bf16 v[116:119], v[20:23], v[84:87], v[116:119]
    s_waitcnt vmcnt(9)
    buffer_load_dwordx4 v[188:191], v2, s[20:23], s42 offen offset:2048 nt
    v_perm_b32 v25, v144, v140, s43
    v_perm_b32 v33, v145, v141, s43
    v_perm_b32 v41, v146, v142, s43
    v_perm_b32 v49, v147, v143, s43
    v_cndmask_b32 v16, 0, v12, s[50:51]
    v_cndmask_b32 v17, 0, v13, s[50:51]
    v_cndmask_b32 v18, 0, v14, s[50:51]
    v_cndmask_b32 v19, 0, v15, s[50:51]
    s_waitcnt lgkmcnt(0)
    v_fma_f32 v120, v120, s45, -v6
    v_fma_f32 v121, v121, s45, -v6
    v_fma_f32 v122, v122, s45, -v6
    v_fma_f32 v123, v123, s45, -v6
    buffer_load_dwordx4 v[192:195], v2, s[20:23], s42 offen offset:3072 nt
    s_add_u32 s42, s42, 12288
    s_and_b32 s42, s42, 524287
    v_perm_b32 v29, v144, v140, s44
    v_perm_b32 v37, v145, v141, s44
    v_perm_b32 v45, v146, v142, s44
    v_perm_b32 v53, v147, v143, s44
    v_fma_f32 v124, v124, s45, -v6
    v_fma_f32 v125, v125, s45, -v6
    v_fma_f32 v126, v126, s45, -v6
    v_fma_f32 v127, v127, s45, -v6
    v_exp_f32 v120, v120
    v_exp_f32 v121, v121
    s_waitcnt vmcnt(9)
    buffer_load_dwordx4 v[132:135], v2, s[20:23], s42 offen offset:0 nt
    v_perm_b32 v26, v152, v148, s43
    v_perm_b32 v34, v153, v149, s43
    v_perm_b32 v42, v154, v150, s43
    v_perm_b32 v50, v155, v151, s43
    buffer_load_dwordx4 v[136:139], v2, s[20:23], s42 offen offset:1024 nt
    v_perm_b32 v30, v152, v148, s44
    v_perm_b32 v38, v153, v149, s44
    v_perm_b32 v46, v154, v150, s44
    v_perm_b32 v54, v155, v151, s44
    s_waitcnt vmcnt(9)
    buffer_load_dwordx4 v[140:143], v2, s[20:23], s42 offen offset:2048 nt
    v_perm_b32 v27, v160, v156, s43
    v_perm_b32 v35, v161, v157, s43
    v_perm_b32 v43, v162, v158, s43
    v_perm_b32 v51, v163, v159, s43
    v_mfma_f32_16x16x32_bf16 v[88:91], v[16:19], v[24:27], v[88:91]
    v_mfma_f32_16x16x32_bf16 v[96:99], v[16:19], v[32:35], v[96:99]
    buffer_load_dwordx4 v[144:147], v2, s[20:23], s42 offen offset:3072 nt
    s_add_u32 s42, s42, 4096
    v_perm_b32 v31, v160, v156, s44
    v_perm_b32 v39, v161, v157, s44
    v_perm_b32 v47, v162, v158, s44
    v_perm_b32 v55, v163, v159, s44
    v_mfma_f32_16x16x32_bf16 v[104:107], v[16:19], v[40:43], v[104:107]
    v_mfma_f32_16x16x32_bf16 v[112:115], v[16:19], v[48:51], v[112:115]
    s_waitcnt vmcnt(9)
    buffer_load_dwordx4 v[148:151], v2, s[20:23], s42 offen offset:0 nt
    v_perm_b32 v56, v168, v164, s43
    v_perm_b32 v64, v169, v165, s43
    v_perm_b32 v72, v170, v166, s43
    v_perm_b32 v80, v171, v167, s43
    v_mfma_f32_16x16x32_bf16 v[92:95], v[16:19], v[28:31], v[92:95]
    v_mfma_f32_16x16x32_bf16 v[100:103], v[16:19], v[36:39], v[100:103]
    buffer_load_dwordx4 v[152:155], v2, s[20:23], s42 offen offset:1024 nt
    v_perm_b32 v60, v168, v164, s44
    v_perm_b32 v68, v169, v165, s44
    v_perm_b32 v76, v170, v166, s44
    v_perm_b32 v84, v171, v167, s44
    v_mfma_f32_16x16x32_bf16 v[108:111], v[16:19], v[44:47], v[108:111]
    v_mfma_f32_16x16x32_bf16 v[116:119], v[16:19], v[52:55], v[116:119]
    s_waitcnt vmcnt(9)
    buffer_load_dwordx4 v[156:159], v2, s[20:23], s42 offen offset:2048 nt
    v_perm_b32 v57, v176, v172, s43
    v_perm_b32 v65, v177, v173, s43
    v_perm_b32 v73, v178, v174, s43
    v_perm_b32 v81, v179, v175, s43
    v_cndmask_b32 v20, 0, v12, s[52:53]
    v_cndmask_b32 v21, 0, v13, s[52:53]
    v_cndmask_b32 v22, 0, v14, s[52:53]
    v_cndmask_b32 v23, 0, v15, s[52:53]
    v_exp_f32 v122, v122
    v_exp_f32 v123, v123
    buffer_load_dwordx4 v[160:163], v2, s[20:23], s42 offen offset:3072 nt
    s_add_u32 s42, s42, 12288
    s_and_b32 s42, s42, 524287
    v_perm_b32 v61, v176, v172, s44
    v_perm_b32 v69, v177, v173, s44
    v_perm_b32 v77, v178, v174, s44
    v_perm_b32 v85, v179, v175, s44
    v_exp_f32 v124, v124
    v_exp_f32 v125, v125
    v_exp_f32 v126, v126
    v_exp_f32 v127, v127
    s_waitcnt vmcnt(9)
    buffer_load_dwordx4 v[164:167], v2, s[20:23], s42 offen offset:0 nt
    v_perm_b32 v58, v184, v180, s43
    v_perm_b32 v66, v185, v181, s43
    v_perm_b32 v74, v186, v182, s43
    v_perm_b32 v82, v187, v183, s43
    s_branch L_loop1
L_done1:
    buffer_load_dwordx4 v[160:163], v2, s[20:23], s42 offen offset:3072 nt
    s_add_u32 s42, s42, 12288
    s_and_b32 s42, s42, 524287
    v_bfe_u32 v130, v0, 4, 2
    v_lshlrev_b32 v130, 3, v130
    buffer_load_dwordx4 v[208:211], v2, s[28:31], s54 offen offset:0
    buffer_load_dwordx4 v[212:215], v2, s[28:31], s54 offen offset:1024
    buffer_load_dwordx2 v[216:217], v130, s[28:31], s54 offen offset:2048
    v_perm_b32 v61, v176, v172, s44
    v_perm_b32 v69, v177, v173, s44
    v_perm_b32 v77, v178, v174, s44
    v_perm_b32 v85, v179, v175, s44
    v_add_f32 v120, v120, v122
    v_add_f32 v124, v124, v126
    v_add_f32 v120, v120, v124
    v_add_f32 v7, v7, v120
    ds_read_b128 v[120:123], v129 offset:3072
    ds_read_b128 v[124:127], v129 offset:4096
    v_add_u32 v129, 2048, v129
    s_waitcnt vmcnt(12)
    buffer_load_dwordx4 v[164:167], v2, s[20:23], s42 offen offset:0 nt
    v_perm_b32 v58, v184, v180, s43
    v_perm_b32 v66, v185, v181, s43
    v_perm_b32 v74, v186, v182, s43
    v_perm_b32 v82, v187, v183, s43
    buffer_load_dwordx4 v[168:171], v2, s[20:23], s42 offen offset:1024 nt
    v_perm_b32 v62, v184, v180, s44
    v_perm_b32 v70, v185, v181, s44
    v_perm_b32 v78, v186, v182, s44
    v_perm_b32 v86, v187, v183, s44
    s_waitcnt vmcnt(12)
    buffer_load_dwordx4 v[172:175], v2, s[20:23], s42 offen offset:2048 nt
    v_perm_b32 v59, v192, v188, s43
    v_perm_b32 v67, v193, v189, s43
    v_perm_b32 v75, v194, v190, s43
    v_perm_b32 v83, v195, v191, s43
    v_mfma_f32_16x16x32_bf16 v[88:91], v[20:23], v[56:59], v[88:91]
    v_mfma_f32_16x16x32_bf16 v[96:99], v[20:23], v[64:67], v[96:99]
    buffer_load_dwordx4 v[176:179], v2, s[20:23], s42 offen offset:3072 nt
    s_add_u32 s42, s42, 4096
    v_perm_b32 v63, v192, v188, s44
    v_perm_b32 v71, v193, v189, s44
    v_perm_b32 v79, v194, v190, s44
    v_perm_b32 v87, v195, v191, s44
    v_mfma_f32_16x16x32_bf16 v[104:107], v[20:23], v[72:75], v[104:107]
    v_mfma_f32_16x16x32_bf16 v[112:115], v[20:23], v[80:83], v[112:115]
    s_waitcnt vmcnt(12)
    buffer_load_dwordx4 v[180:183], v2, s[20:23], s42 offen offset:0 nt
    v_perm_b32 v24, v136, v132, s43
    v_perm_b32 v32, v137, v133, s43
    v_perm_b32 v40, v138, v134, s43
    v_perm_b32 v48, v139, v135, s43
    v_mfma_f32_16x16x32_bf16 v[92:95], v[20:23], v[60:63], v[92:95]
    v_mfma_f32_16x16x32_bf16 v[100:103], v[20:23], v[68:71], v[100:103]
    buffer_load_dwordx4 v[184:187], v2, s[20:23], s42 offen offset:1024 nt
    v_perm_b32 v28, v136, v132, s44
    v_perm_b32 v36, v137, v133, s44
    v_perm_b32 v44, v138, v134, s44
    v_perm_b32 v52, v139, v135, s44
    v_mfma_f32_16x16x32_bf16 v[108:111], v[20:23], v[76:79], v[108:111]
    v_mfma_f32_16x16x32_bf16 v[116:119], v[20:23], v[84:87], v[116:119]
    s_waitcnt vmcnt(12)
    buffer_load_dwordx4 v[188:191], v2, s[20:23], s42 offen offset:2048 nt
    v_perm_b32 v25, v144, v140, s43
    v_perm_b32 v33, v145, v141, s43
    v_perm_b32 v41, v146, v142, s43
    v_perm_b32 v49, v147, v143, s43
    v_cndmask_b32 v16, 0, v12, s[50:51]
    v_cndmask_b32 v17, 0, v13, s[50:51]
    v_cndmask_b32 v18, 0, v14, s[50:51]
    v_cndmask_b32 v19, 0, v15, s[50:51]
    s_waitcnt lgkmcnt(0)
    v_fma_f32 v120, v120, s45, -v6
    v_fma_f32 v121, v121, s45, -v6
    v_fma_f32 v122, v122, s45, -v6
    v_fma_f32 v123, v123, s45, -v6
    buffer_load_dwordx4 v[192:195], v2, s[20:23], s42 offen offset:3072 nt
    s_add_u32 s42, s42, 12288
    s_and_b32 s42, s42, 524287
    v_perm_b32 v29, v144, v140, s44
    v_perm_b32 v37, v145, v141, s44
    v_perm_b32 v45, v146, v142, s44
    v_perm_b32 v53, v147, v143, s44
    v_fma_f32 v124, v124, s45, -v6
    v_fma_f32 v125, v125, s45, -v6
    v_fma_f32 v126, v126, s45, -v6
    v_fma_f32 v127, v127, s45, -v6
    v_exp_f32 v120, v120
    v_exp_f32 v121, v121
    v_add_f32_dpp v7, v7, v7 row_ror:4 row_mask:0xf bank_mask:0xf
    s_nop 1
    v_add_f32_dpp v7, v7, v7 row_ror:8 row_mask:0xf bank_mask:0xf
    v_mov_b32 v3, v7
    s_nop 1
    v_permlane32_swap_b32 v3, v7
    s_nop 0
    v_add_f32 v7, v3, v7
    v_mov_b32 v3, v7
    s_nop 1
    v_permlane16_swap_b32 v3, v7
    s_nop 0
    v_add_f32 v7, v3, v7
    s_lshl_b32 s40, s38, 5
    v_and_b32 v4, 3, v0
    v_lshl_add_u32 v4, v4, 3, s40
    ds_write_b64 v4, v[6:7] offset:2048
    v_bfe_u32 v4, v0, 4, 2
    v_lshlrev_b32 v4, 3, v4
    v_add_u32 v3, s40, v4
    v_and_b32 v5, 0x3c, v0
    v_lshrrev_b32 v8, 2, v5
    v_and_b32 v8, 3, v8
    v_and_b32 v5, 0x30, v5
    v_add3_u32 v5, v5, v8, 12
    v_lshlrev_b32 v5, 2, v5
    s_lshl_b32 s40, s36, 2
    v_mov_b32 v8, s40
    v_mov_b32 v9, 1
    v_mov_b32 v10, 0
    s_cmp_lg_u32 s38, 0
    s_waitcnt lgkmcnt(0)
    s_barrier
    s_cbranch_scc1 L_noticket
    s_mov_b64 exec, 1
    global_atomic_add v10, v8, v9, s[12:13] sc0
    s_mov_b64 exec, -1
L_noticket:
    v_mov_b32 v207, 0
    ds_read_b32 v206, v207 offset:2176
    ds_read_b64 v[252:253], v4 offset:2048
    ds_read_b64 v[254:255], v4 offset:2080
    ds_read_b32 v11, v3 offset:2048
    ds_bpermute_b32 v20, v5, v12
    ds_bpermute_b32 v21, v5, v13
    ds_bpermute_b32 v22, v5, v14
    ds_bpermute_b32 v23, v5, v15
    s_mov_b32 s58, 0x20000
    s_waitcnt vmcnt(13)
    v_perm_b32 v26, v152, v148, s43
    v_perm_b32 v34, v153, v149, s43
    v_perm_b32 v42, v154, v150, s43
    v_perm_b32 v50, v155, v151, s43
    s_waitcnt vmcnt(12)
    v_perm_b32 v30, v152, v148, s44
    v_perm_b32 v38, v153, v149, s44
    v_perm_b32 v46, v154, v150, s44
    v_perm_b32 v54, v155, v151, s44
    s_waitcnt vmcnt(11)
    v_perm_b32 v27, v160, v156, s43
    v_perm_b32 v35, v161, v157, s43
    v_perm_b32 v43, v162, v158, s43
    v_perm_b32 v51, v163, v159, s43
    v_mfma_f32_16x16x32_bf16 v[88:91], v[16:19], v[24:27], v[88:91]
    v_mfma_f32_16x16x32_bf16 v[96:99], v[16:19], v[32:35], v[96:99]
    v_mfma_f32_16x16x32_bf16 v[104:107], v[16:19], v[40:43], v[104:107]
    v_mfma_f32_16x16x32_bf16 v[112:115], v[16:19], v[48:51], v[112:115]
    s_waitcnt vmcnt(7)
    v_perm_b32 v31, v160, v156, s44
    v_perm_b32 v39, v161, v157, s44
    v_perm_b32 v47, v162, v158, s44
    v_perm_b32 v55, v163, v159, s44
    v_mfma_f32_16x16x32_bf16 v[92:95], v[16:19], v[28:31], v[92:95]
    v_mfma_f32_16x16x32_bf16 v[100:103], v[16:19], v[36:39], v[100:103]
    v_mfma_f32_16x16x32_bf16 v[108:111], v[16:19], v[44:47], v[108:111]
    v_mfma_f32_16x16x32_bf16 v[116:119], v[16:19], v[52:55], v[116:119]
    s_waitcnt vmcnt(6)
    v_perm_b32 v56, v168, v164, s43
    v_perm_b32 v64, v169, v165, s43
    v_perm_b32 v72, v170, v166, s43
    v_perm_b32 v80, v171, v167, s43
    s_waitcnt lgkmcnt(0)
    v_max_f32 v204, v252, v254
    v_sub_f32 v252, v252, v204
    v_sub_f32 v254, v254, v204
    v_sub_f32 v11, v11, v204
    v_exp_f32 v252, v252
    v_exp_f32 v254, v254
    v_exp_f32 v11, v11
    v_mul_f32 v205, v252, v253
    v_fmac_f32 v205, v254, v255
    v_min_u32 v204, 0xfffffffe, v204
    v_min_u32 v205, 0xfffffffe, v205
    v_readfirstlane_b32 s64, v206
    v_permlane32_swap_b32 v88, v90
    v_permlane32_swap_b32 v89, v91
    v_permlane32_swap_b32 v92, v94
    v_permlane32_swap_b32 v93, v95
    v_permlane32_swap_b32 v96, v98
    v_permlane32_swap_b32 v97, v99
    v_permlane32_swap_b32 v100, v102
    v_permlane32_swap_b32 v101, v103
    v_permlane32_swap_b32 v104, v106
    v_permlane32_swap_b32 v105, v107
    v_permlane32_swap_b32 v108, v110
    v_permlane32_swap_b32 v109, v111
    v_permlane32_swap_b32 v112, v114
    v_permlane32_swap_b32 v113, v115
    v_permlane32_swap_b32 v116, v118
    v_permlane32_swap_b32 v117, v119
    v_add_f32 v88, v88, v90
    v_add_f32 v89, v89, v91
    v_add_f32 v92, v92, v94
    v_add_f32 v93, v93, v95
    v_add_f32 v96, v96, v98
    v_add_f32 v97, v97, v99
    v_add_f32 v100, v100, v102
    v_add_f32 v101, v101, v103
    s_waitcnt vmcnt(5)
    v_perm_b32 v60, v168, v164, s44
    v_perm_b32 v68, v169, v165, s44
    v_perm_b32 v76, v170, v166, s44
    v_perm_b32 v84, v171, v167, s44
    v_add_f32 v104, v104, v106
    v_add_f32 v105, v105, v107
    v_add_f32 v108, v108, v110
    v_add_f32 v109, v109, v111
    v_add_f32 v112, v112, v114
    v_add_f32 v113, v113, v115
    v_add_f32 v116, v116, v118
    v_add_f32 v117, v117, v119
    v_permlane16_swap_b32 v88, v89
    v_permlane16_swap_b32 v92, v93
    v_permlane16_swap_b32 v96, v97
    v_permlane16_swap_b32 v100, v101
    v_permlane16_swap_b32 v104, v105
    v_permlane16_swap_b32 v108, v109
    v_permlane16_swap_b32 v112, v113
    v_permlane16_swap_b32 v116, v117
    v_add_f32 v88, v88, v89
    v_add_f32 v92, v92, v93
    v_add_f32 v96, v96, v97
    v_add_f32 v100, v100, v101
    s_waitcnt vmcnt(4)
    v_perm_b32 v57, v176, v172, s43
    v_perm_b32 v65, v177, v173, s43
    v_perm_b32 v73, v178, v174, s43
    v_perm_b32 v81, v179, v175, s43
    v_add_f32 v104, v104, v105
    v_add_f32 v108, v108, v109
    v_add_f32 v112, v112, v113
    v_add_f32 v116, v116, v117
    s_waitcnt vmcnt(3)
    v_perm_b32 v61, v176, v172, s44
    v_perm_b32 v69, v177, v173, s44
    v_perm_b32 v77, v178, v174, s44
    v_perm_b32 v85, v179, v175, s44
    s_waitcnt vmcnt(2)
    v_perm_b32 v58, v184, v180, s43
    v_perm_b32 v66, v185, v181, s43
    v_perm_b32 v74, v186, v182, s43
    v_perm_b32 v82, v187, v183, s43
    s_waitcnt vmcnt(1)
    v_perm_b32 v62, v184, v180, s44
    v_perm_b32 v70, v185, v181, s44
    v_perm_b32 v78, v186, v182, s44
    v_perm_b32 v86, v187, v183, s44
    s_waitcnt vmcnt(0)
    v_readfirstlane_b32 s59, v10
    v_perm_b32 v59, v192, v188, s43
    v_perm_b32 v67, v193, v189, s43
    v_perm_b32 v75, v194, v190, s43
    v_perm_b32 v83, v195, v191, s43
    s_cmp_lg_u32 s59, 3
    s_cbranch_scc1 L_nopoll
    buffer_load_dwordx2 v[216:217], v130, s[28:31], s55 offen offset:2048 sc1
    buffer_load_dwordx2 v[228:229], v130, s[28:31], s56 offen offset:2048 sc1
    buffer_load_dwordx2 v[240:241], v130, s[28:31], s57 offen offset:2048 sc1
    buffer_load_dwordx4 v[208:211], v2, s[28:31], s55 offen sc1
    buffer_load_dwordx4 v[212:215], v2, s[28:31], s55 offen offset:1024 sc1
    buffer_load_dwordx4 v[220:223], v2, s[28:31], s56 offen sc1
    buffer_load_dwordx4 v[224:227], v2, s[28:31], s56 offen offset:1024 sc1
    buffer_load_dwordx4 v[232:235], v2, s[28:31], s57 offen sc1
    buffer_load_dwordx4 v[236:239], v2, s[28:31], s57 offen offset:1024 sc1
L_nopoll:
    v_perm_b32 v63, v192, v188, s44
    v_perm_b32 v71, v193, v189, s44
    v_perm_b32 v79, v194, v190, s44
    v_perm_b32 v87, v195, v191, s44
    v_mfma_f32_16x16x32_bf16 v[88:91], v[20:23], v[56:59], v[88:91]
    v_mfma_f32_16x16x32_bf16 v[96:99], v[20:23], v[64:67], v[96:99]
    v_mfma_f32_16x16x32_bf16 v[104:107], v[20:23], v[72:75], v[104:107]
    v_mfma_f32_16x16x32_bf16 v[112:115], v[20:23], v[80:83], v[112:115]
    v_mfma_f32_16x16x32_bf16 v[92:95], v[20:23], v[60:63], v[92:95]
    v_mfma_f32_16x16x32_bf16 v[100:103], v[20:23], v[68:71], v[100:103]
    v_mfma_f32_16x16x32_bf16 v[108:111], v[20:23], v[76:79], v[108:111]
    v_mfma_f32_16x16x32_bf16 v[116:119], v[20:23], v[84:87], v[116:119]
    s_cmp_lg_u32 s38, 0
    s_cbranch_scc1 L_send
    s_barrier
    ds_read_b128 v[244:247], v2 offset:0
    ds_read_b128 v[248:251], v2 offset:1024
    s_cmp_eq_u32 s59, 3
    s_waitcnt lgkmcnt(0)
    v_fma_f32 v196, v11, v88, v244
    v_fma_f32 v198, v11, v96, v246
    v_fma_f32 v200, v11, v104, v248
    v_fma_f32 v202, v11, v112, v250
    v_fma_f32 v197, v11, v92, v245
    v_fma_f32 v199, v11, v100, v247
    v_fma_f32 v201, v11, v108, v249
    v_fma_f32 v203, v11, v116, v251
    s_cbranch_scc1 L_again1
    v_min_u32 v196, 0xfffffffe, v196
    v_min_u32 v197, 0xfffffffe, v197
    v_min_u32 v198, 0xfffffffe, v198
    v_min_u32 v199, 0xfffffffe, v199
    v_min_u32 v200, 0xfffffffe, v200
    v_min_u32 v201, 0xfffffffe, v201
    v_min_u32 v202, 0xfffffffe, v202
    v_min_u32 v203, 0xfffffffe, v203
    s_cmp_eq_u32 s64, 1
    s_cbranch_scc0 L_pubfar
    buffer_store_dwordx4 v[196:199], v2, s[28:31], s54 offen
    buffer_store_dwordx4 v[200:203], v2, s[28:31], s54 offen offset:1024
    s_mov_b32 exec_lo, 0x10001
    s_mov_b32 exec_hi, 0x10001
    buffer_store_dwordx2 v[204:205], v130, s[28:31], s54 offen offset:2048
    s_mov_b64 exec, -1
    s_branch L_end
L_pubfar:
    buffer_store_dwordx4 v[196:199], v2, s[28:31], s54 offen sc1
    buffer_store_dwordx4 v[200:203], v2, s[28:31], s54 offen offset:1024 sc1
    s_mov_b32 exec_lo, 0x10001
    s_mov_b32 exec_hi, 0x10001
    buffer_store_dwordx2 v[204:205], v130, s[28:31], s54 offen offset:2048 sc1
    s_mov_b64 exec, -1
    s_branch L_end
L_send:
    v_mul_f32 v244, v11, v88
    v_mul_f32 v246, v11, v96
    v_mul_f32 v248, v11, v104
    v_mul_f32 v250, v11, v112
    v_mul_f32 v245, v11, v92
    v_mul_f32 v247, v11, v100
    v_mul_f32 v249, v11, v108
    v_mul_f32 v251, v11, v116
    ds_write_b128 v2, v[244:247] offset:0
    ds_write_b128 v2, v[248:251] offset:1024
    s_waitcnt lgkmcnt(0)
    s_barrier
    s_branch L_end
L_again0:
    buffer_load_dwordx2 v[216:217], v130, s[28:31], s55 offen offset:2048 sc1
    buffer_load_dwordx2 v[228:229], v130, s[28:31], s56 offen offset:2048 sc1
    buffer_load_dwordx2 v[240:241], v130, s[28:31], s57 offen offset:2048 sc1
    buffer_load_dwordx4 v[208:211], v2, s[28:31], s55 offen sc1
    buffer_load_dwordx4 v[212:215], v2, s[28:31], s55 offen offset:1024 sc1
    buffer_load_dwordx4 v[220:223], v2, s[28:31], s56 offen sc1
    buffer_load_dwordx4 v[224:227], v2, s[28:31], s56 offen offset:1024 sc1
    buffer_load_dwordx4 v[232:235], v2, s[28:31], s57 offen sc1
    buffer_load_dwordx4 v[236:239], v2, s[28:31], s57 offen offset:1024 sc1
L_again1:
    s_waitcnt vmcnt(6)
    v_max3_u32 v4, v216, v228, v240
    v_max3_f32 v3, v204, v216, v228
    v_cmp_eq_u32 vcc, -1, v4
    v_max_f32 v3, v3, v240
    s_sub_u32 s58, s58, 1
    s_cbranch_scc1 L_go0
    s_cbranch_vccnz L_again0
L_go0:
    v_sub_f32 v24, v204, v3
    v_sub_f32 v25, v216, v3
    v_sub_f32 v26, v228, v3
    v_sub_f32 v27, v240, v3
    v_exp_f32 v24, v24
    v_exp_f32 v25, v25
    v_exp_f32 v26, v26
    v_exp_f32 v27, v27
    s_nop 0
    v_mul_f32 v4, v24, v205
    v_fmac_f32 v4, v25, v217
    v_fmac_f32 v4, v26, v229
    v_fmac_f32 v4, v27, v241
    v_rcp_f32 v4, v4
    s_nop 0
    v_mul_f32 v24, v24, v4
    v_mul_f32 v25, v25, v4
    v_mul_f32 v26, v26, v4
    v_mul_f32 v27, v27, v4
    v_mul_f32 v28, v24, v196
    v_mul_f32 v29, v24, v197
    v_mul_f32 v30, v24, v198
    v_mul_f32 v31, v24, v199
    v_mul_f32 v32, v24, v200
    v_mul_f32 v33, v24, v201
    v_mul_f32 v34, v24, v202
    v_mul_f32 v35, v24, v203
    s_waitcnt vmcnt(4)
    v_fmac_f32 v28, v25, v208
    v_fmac_f32 v29, v25, v209
    v_fmac_f32 v30, v25, v210
    v_fmac_f32 v31, v25, v211
    v_fmac_f32 v32, v25, v212
    v_fmac_f32 v33, v25, v213
    v_fmac_f32 v34, v25, v214
    v_fmac_f32 v35, v25, v215
    s_waitcnt vmcnt(2)
    v_fmac_f32 v28, v26, v220
    v_fmac_f32 v29, v26, v221
    v_fmac_f32 v30, v26, v222
    v_fmac_f32 v31, v26, v223
    v_fmac_f32 v32, v26, v224
    v_fmac_f32 v33, v26, v225
    v_fmac_f32 v34, v26, v226
    v_fmac_f32 v35, v26, v227
    s_waitcnt vmcnt(0)
    v_fmac_f32 v28, v27, v232
    v_fmac_f32 v29, v27, v233
    v_fmac_f32 v30, v27, v234
    v_fmac_f32 v31, v27, v235
    v_fmac_f32 v32, v27, v236
    v_fmac_f32 v33, v27, v237
    v_fmac_f32 v34, v27, v238
    v_fmac_f32 v35, v27, v239
    v_cmp_u_f32 vcc, v28, v29
    v_cmp_u_f32 s[62:63], v30, v31
    v_cvt_pk_bf16_f32 v36, v28, v29
    s_or_b64 s[62:63], s[62:63], vcc
    v_cmp_u_f32 vcc, v32, v33
    v_cvt_pk_bf16_f32 v37, v30, v31
    s_or_b64 s[62:63], s[62:63], vcc
    v_cmp_u_f32 vcc, v34, v35
    v_cvt_pk_bf16_f32 v38, v32, v33
    v_cvt_pk_bf16_f32 v39, v34, v35
    s_or_b64 s[62:63], s[62:63], vcc
    s_cbranch_scc0 L_store
    v_max3_u32 v3, v208, v209, v210
    v_max3_u32 v4, v211, v212, v213
    v_max3_u32 v3, v3, v214, v215
    v_max3_u32 v4, v4, v216, v217
    v_max3_u32 v3, v3, v220, v221
    v_max3_u32 v4, v4, v222, v223
    v_max3_u32 v3, v3, v224, v225
    v_max3_u32 v4, v4, v226, v227
    v_max3_u32 v3, v3, v228, v229
    v_max3_u32 v4, v4, v232, v233
    v_max3_u32 v3, v3, v234, v235
    v_max3_u32 v4, v4, v236, v237
    v_max3_u32 v3, v3, v238, v239
    v_max3_u32 v4, v4, v240, v241
    v_max_u32 v3, v3, v4
    v_cmp_eq_u32 vcc, -1, v3
    s_cmp_lt_i32 s58, 0
    s_cbranch_scc1 L_store
    s_nop 2
    s_cbranch_vccnz L_again0
    s_branch L_store
L_store:
    buffer_store_dwordx4 v[36:39], v2, s[32:35], s61 offen
L_end:
L_exit:
    s_endpgm
L_helper:
    s_mov_b32 s28, s14
    s_mov_b32 s29, s15
    s_mov_b32 s30, 1048576
    s_mov_b32 s31, 0x20000
    s_lshl_b32 s58, s36, 14
    s_lshl_b32 s54, s37, 12
    s_add_u32 s54, s54, s58
    v_bfe_u32 v130, v0, 4, 2
    v_lshlrev_b32 v130, 3, v130
    v_lshrrev_b32 v3, 4, v2
    v_lshlrev_b32 v4, 2, v3
    v_add_u32 v16, s54, v4
    v_lshlrev_b32 v3, 12, v3
    v_xor_b32 v17, v3, v16
    v_mov_b32 v12, -1
    v_mov_b32 v13, -1
    v_mov_b32 v14, -1
    v_mov_b32 v15, -1
    s_getreg_b32 s40, hwreg(HW_REG_XCC_ID, 0, 4)
    s_mov_b64 exec, 14
    buffer_load_dword v18, v16, s[28:31], 0 offen offset:3200 sc1
    s_mov_b64 exec, -1
    buffer_store_dwordx4 v[12:15], v2, s[28:31], s54 offen
    buffer_store_dwordx4 v[12:15], v2, s[28:31], s54 offen offset:1024
    s_mov_b32 exec_lo, 0x10001
    s_mov_b32 exec_hi, 0x10001
    buffer_store_dwordx2 v[12:13], v130, s[28:31], s54 offen offset:2048
    s_mov_b64 exec, -1
    s_mov_b64 exec, 14
    s_waitcnt vmcnt(0)
    v_add_u32 v19, 16, v18
    v_and_b32 v19, -16, v19
    buffer_store_dword v19, v16, s[28:31], 0 offen offset:3072
    v_or_b32 v18, s40, v19
    s_mov_b32 s60, 2
L_echo:
    s_sleep 16
    buffer_load_dword v20, v17, s[28:31], 0 offen offset:3072 sc1
    s_waitcnt vmcnt(0)
    v_and_b32 v20, -16, v20
    v_or_b32 v20, s40, v20
    buffer_store_dword v20, v17, s[28:31], 0 offen offset:3200
    s_sub_u32 s60, s60, 1
    s_cbranch_scc0 L_echo
    s_sleep 16
    buffer_load_dword v21, v16, s[28:31], 0 offen offset:3200 sc1
    s_waitcnt vmcnt(0)
    v_cmp_eq_u32 vcc, v21, v18
    s_mov_b64 exec, -1
    v_mov_b32 v3, 0
    s_cmp_eq_u64 vcc, 14
    s_cselect_b32 s39, 1, 0
    v_mov_b32 v4, s39
    ds_write_b32 v3, v4 offset:2176
    s_cmp_eq_u32 s39, 1
    s_cbranch_scc1 L_hend
    buffer_store_dwordx4 v[12:15], v2, s[28:31], s54 offen sc1
    buffer_store_dwordx4 v[12:15], v2, s[28:31], s54 offen offset:1024 sc1
    s_mov_b32 exec_lo, 0x10001
    s_mov_b32 exec_hi, 0x10001
    buffer_store_dwordx2 v[12:13], v130, s[28:31], s54 offen offset:2048 sc1
    s_mov_b64 exec, -1
L_hend:
    s_waitcnt vmcnt(0) lgkmcnt(0)
    s_endpgm
.section .rodata,"a"
.p2align 6
.amdhsa_kernel standalone__gqa_softmax__decode_kernel
  .amdhsa_next_free_vgpr 256
  .amdhsa_next_free_sgpr 66
  .amdhsa_accum_offset 256
  .amdhsa_group_segment_fixed_size 0
  .amdhsa_kernarg_size 48
  .amdhsa_user_sgpr_count 2
  .amdhsa_user_sgpr_kernarg_segment_ptr 1
  .amdhsa_system_sgpr_workgroup_id_x 1
.end_amdhsa_kernel
```
